```python
import torch

def _softmax(x, axis=-1):
    return torch.softmax(x, dim=axis)
def _gelu(x):
    return torch.nn.functional.gelu(x, approximate="tanh")
def _silu(x):
    return torch.nn.functional.silu(x)
def _sigmoid(x):
    return torch.sigmoid(x)
def _layernorm(x, axis=-1, eps=1e-5):
    m = x.mean(dim=axis, keepdim=True)
    v = x.var(dim=axis, keepdim=True, unbiased=False)
    return (x - m) / torch.sqrt(v + eps)
def _scatter_add(tgt, idx, src, axis=0):
    return tgt.clone().index_add_(axis, idx, src)
def _segment_sum(src, seg, n):
    out = torch.zeros((n,) + src.shape[1:], dtype=src.dtype)
    return out.index_add_(0, seg, src)
def _pad(x, pw):
    flat = tuple(v for pair in reversed(pw) for v in pair)
    return torch.nn.functional.pad(x, flat)

kernel_name = 'gated_mix__linear_attn_block__spectral_gfnet__prompt'

def setup_inputs():

    _w = (lambda a: (lambda t: t.to(torch.bfloat16) if t.is_floating_point() else t)(torch.as_tensor(a)))
    def _A_setup():
        B, S, D = 1, 2048, 512
        return {
            "x": _w((lambda *s: torch.randn(*s, dtype=torch.bfloat16) * 0.05)(B, S, D)),
            "wqkv": _w((lambda *s: torch.randn(*s, dtype=torch.bfloat16) * 0.4)(D, 3 * D)),
            "wo": _w((lambda *s: torch.randn(*s, dtype=torch.bfloat16) * 0.05)(D, D)),
        }
    _A_in = _A_setup()

    def _B_setup():
        B, S, D = 1, 2048, 512
        Df = D // 2 + 1
        return {
            "x": _w((lambda *s: torch.randn(*s, dtype=torch.bfloat16) * 0.05)(B, S, D)),
            "w_r": _w((lambda *s: torch.randn(*s, dtype=torch.bfloat16) * 1.6)(S, Df) * 0.02),
            "w_i": _w((lambda *s: torch.randn(*s, dtype=torch.bfloat16) * 1.6)(S, Df) * 0.02),
        }
    _B_in = _B_setup()

    return {
        "A_x": _A_in["x"],
        "A_wqkv": _A_in["wqkv"],
        "A_wo": _A_in["wo"],
        "B_x": _B_in["x"],
        "B_w_r": _B_in["w_r"],
        "B_w_i": _B_in["w_i"],
        "gate_w": _w((lambda *s: torch.randn(*s, dtype=torch.bfloat16) * 0.05)(512) * 16.0),
    }

def reference(A_x, A_wqkv, A_wo, B_x, B_w_r, B_w_i, gate_w):
    def _A_ref(x, wqkv, wo):
        B, S, D = x.shape
        H = 32; Dh = D // H
        qkv = (lambda x, *d: x.permute(*d))((x @ wqkv).reshape(B, S, 3, H, Dh), 2, 0, 3, 1, 4)
        q, k, v = qkv[0], qkv[1], qkv[2]
        phi = lambda t: torch.where(t > 0, t + 1, torch.exp(t)) + 1e-6
        pq, pk = phi(q), phi(k)
        kv = torch.einsum("bhsd,bhse->bhde", pk, v)
        z = torch.einsum("bhsd->bhd", pk)
        num = torch.einsum("bhqd,bhde->bhqe", pq, kv)
        den = torch.einsum("bhqd,bhd->bhq", pq, z)[..., None] + 1e-6
        o = num / den
        return (lambda x, *d: x.permute(*d))(o, 0, 2, 1, 3).reshape(B, S, D) @ wo

    def _B_ref(x, w_r, w_i):
        B, S, D = x.shape
        X = (lambda x, axes=(-2,-1): torch.fft.rfft2(x.float(), dim=axes))(x, axes=(-2, -1))
        W = w_r + 1j * w_i
        X = X * W
        y = (lambda x, s, axes=(-2,-1): torch.fft.irfft2(x, s=s, dim=axes).to(torch.bfloat16))(X, (S, D), axes=(-2, -1))
        return y

    x = A_x
    g = _sigmoid((x * gate_w).sum(-1, keepdims=True))
    a = _A_ref(x, A_wqkv, A_wo)
    b = _B_ref(x, B_w_r, B_w_i)
    return g * a + (1 - g) * b
```

```asm
; @launch kernel=gm_k1_kernel grid=(256,1,1) block=(768,1,1) lds=163840
; @launch kernel=gm_k2_kernel grid=(256,1,1) block=(512,1,1) lds=163840
; @launch kernel=gm_k3_kernel grid=(256,1,1) block=(256,1,1) lds=58368
.amdgcn_target "amdgcn-amd-amdhsa--gfx950"
.text
.globl gm_k1_kernel
.p2align 8
.type gm_k1_kernel,@function
gm_k1_kernel:
    s_cmp_ge_u32 s2, 256
    s_cbranch_scc1 K1_END
    s_load_dwordx4 s[4:7], s[0:1], 0
    s_load_dwordx4 s[8:11], s[0:1], 32
    s_load_dwordx2 s[12:13], s[0:1], 48
    s_load_dwordx2 s[14:15], s[0:1], 72
    v_lshrrev_b32 v1, 6, v0
    s_nop 0
    v_readfirstlane_b32 s20, v1
    v_and_b32 v0, 63, v0
    s_bfe_u32 s16, s2, 0x20003
    s_and_b32 s21, s2, 1
    s_lshl_b32 s21, s21, 2
    s_add_u32 s16, s16, s21
    s_lshr_b32 s18, s2, 5
    s_bfe_u32 s21, s2, 0x20001
    s_lshl_b32 s21, s21, 3
    s_add_u32 s18, s18, s21
    s_add_u32 s19, s18, s16
    s_and_b32 s19, s19, 3
    v_lshrrev_b32 v1, 4, v0
    v_and_b32 v2, 15, v0
    s_cmp_lt_u32 s20, 8
    s_nop 1
    s_cbranch_scc1 K1_NOTL
    s_sub_u32 s21, s20, 8
    s_setprio 3
    v_xor_b32 v3, v1, v2
    v_lshlrev_b32 v3, 4, v3
    v_lshl_add_u32 v7, v1, 15, v3
    s_lshl_b32 s56, s18, 10
    s_lshl_b32 s57, s21, 19
    s_add_u32 s56, s56, s57
    s_lshl_b32 s59, s21, 12
    s_add_u32 s57, s59, 98304
    v_xor_b32 v8, 64, v7
    v_add_u32 v8, 130048, v8
    v_xor_b32 v9, 128, v7
    v_add_u32 v9, 260096, v9
    v_xor_b32 v10, 192, v7
    v_add_u32 v10, 390144, v10
    s_waitcnt lgkmcnt(0)
    s_mov_b32 s24, s4
    s_mov_b32 s25, s5
    s_mov_b32 s26, 0x200000
    s_mov_b32 s27, 0x00020000
    s_add_u32 s48, s19, 0
    s_and_b32 s48, s48, 3
    s_lshl_b32 s49, s48, 8
    s_add_u32 s49, s49, s56
    s_lshl_b32 s50, s48, 14
    s_add_u32 m0, s50, s57
    s_nop 0
    buffer_load_dwordx4 v7, s[24:27], s49 offen offset:0 lds
    buffer_load_dwordx4 v8, s[24:27], s49 offen offset:1024 lds
    buffer_load_dwordx4 v9, s[24:27], s49 offen offset:2048 lds
    buffer_load_dwordx4 v10, s[24:27], s49 offen offset:3072 lds
    v_lshrrev_b32 v3, 3, v0
    v_bfe_u32 v4, v0, 4, 1
    v_bfe_u32 v5, v0, 1, 2
    v_xor_b32 v4, v4, v5
    v_lshlrev_b32 v4, 5, v4
    v_and_b32 v5, 1, v0
    v_lshl_add_u32 v4, v5, 4, v4
    v_mul_u32_u24 v3, 3072, v3
    v_add_u32 v11, v3, v4
    v_xor_b32 v12, 64, v11
    v_add_u32 v12, 23552, v12
    s_mov_b32 s28, s6
    s_mov_b32 s29, s7
    s_mov_b32 s30, 0x180000
    s_mov_b32 s31, 0x00020000
    s_mul_i32 s58, s21, 49152
    s_lshl_b32 s60, s16, 7
    s_add_u32 s58, s58, s60
    s_lshl_b32 s59, s21, 11
    s_lshl_b32 s61, s19, 1
    s_mov_b32 s44, s14
    s_mov_b32 s45, s15
    s_mov_b32 s46, 0x1400000
    s_mov_b32 s47, 0x00020000
    s_add_u32 s48, s61, 0
    s_and_b32 s48, s48, 7
    s_mul_i32 s60, s48, 196608
    s_add_u32 s60, s60, s58
    s_add_u32 s60, s60, 1024
    s_add_u32 m0, s59, 0
    s_nop 0
    buffer_load_dwordx4 v11, s[28:31], s60 offen offset:0 lds
    buffer_load_dwordx4 v12, s[28:31], s60 offen offset:1024 lds
    s_add_u32 s60, s60, 1024
    s_add_u32 m0, s59, 8192
    s_nop 0
    buffer_load_dwordx4 v11, s[28:31], s60 offen offset:0 lds
    buffer_load_dwordx4 v12, s[28:31], s60 offen offset:1024 lds
    s_add_u32 s48, s61, 1
    s_and_b32 s48, s48, 7
    s_mul_i32 s60, s48, 196608
    s_add_u32 s60, s60, s58
    s_add_u32 s60, s60, 1024
    s_add_u32 m0, s59, 16384
    s_nop 0
    buffer_load_dwordx4 v11, s[28:31], s60 offen offset:0 lds
    buffer_load_dwordx4 v12, s[28:31], s60 offen offset:1024 lds
    s_add_u32 s60, s60, 1024
    s_add_u32 m0, s59, 24576
    s_nop 0
    buffer_load_dwordx4 v11, s[28:31], s60 offen offset:0 lds
    buffer_load_dwordx4 v12, s[28:31], s60 offen offset:1024 lds
    s_add_u32 s48, s19, 1
    s_and_b32 s48, s48, 3
    s_lshl_b32 s49, s48, 8
    s_add_u32 s49, s49, s56
    s_lshl_b32 s50, s48, 14
    s_add_u32 m0, s50, s57
    s_nop 0
    buffer_load_dwordx4 v7, s[24:27], s49 offen offset:0 lds
    buffer_load_dwordx4 v8, s[24:27], s49 offen offset:1024 lds
    buffer_load_dwordx4 v9, s[24:27], s49 offen offset:2048 lds
    buffer_load_dwordx4 v10, s[24:27], s49 offen offset:3072 lds
    s_mov_b32 s32, s8
    s_mov_b32 s33, s9
    s_mov_b32 s34, 0x101000
    s_mov_b32 s35, 0x00020000
    s_mov_b32 s36, s10
    s_mov_b32 s37, s11
    s_mov_b32 s38, 0x101000
    s_mov_b32 s39, 0x00020000
    s_lshl_b32 s68, s2, 1
    s_add_u32 s68, s68, s21
    s_add_u32 s49, s2, 512
    s_cmp_eq_u32 s21, 2
    s_cselect_b32 s68, s49, s68
    s_cmp_eq_u32 s21, 3
    s_cselect_b32 s68, 1024, s68
    s_lshr_b32 s49, s68, 1
    s_lshr_b32 s50, s49, 3
    s_and_b32 s51, s49, 7
    s_lshl_b32 s51, s51, 8
    s_add_u32 s50, s50, s51
    v_lshl_add_u32 v162, v1, 6, s50
    v_sub_u32 v163, 2048, v162
    v_and_b32 v163, 2047, v163
    v_mul_u32_u24 v162, 514, v162
    v_mul_u32_u24 v163, 514, v163
    s_lshl_b32 s69, s49, 13
    s_add_u32 s69, s69, 5242880
    v_lshlrev_b32 v165, 5, v2
    v_add_u32 v164, v162, v165
    v_sub_u32 v165, v163, v165
    v_add_u32 v165, 482, v165
    v_add_u32 v162, 512, v162
    s_bitcmp1_b32 s68, 0
    s_cselect_b64 s[70:71], -1, 0
    v_cndmask_b32 v164, v164, v165, s[70:71]
    v_cndmask_b32 v163, v163, v162, s[70:71]
    s_mov_b32 s40, s12
    s_mov_b32 s41, s13
    s_mov_b32 s42, 0x400
    s_mov_b32 s43, 0x00020000
    v_and_b32 v3, 31, v0
    v_lshlrev_b32 v3, 5, v3
    buffer_load_dwordx4 v[16:19], v3, s[40:43], 0 offen offset:0
    buffer_load_dwordx4 v[20:23], v3, s[40:43], 0 offen offset:16
    s_waitcnt vmcnt(10)
    s_barrier
    s_add_u32 s48, s19, 2
    s_and_b32 s48, s48, 3
    s_lshl_b32 s49, s48, 8
    s_add_u32 s49, s49, s56
    s_lshl_b32 s50, s48, 14
    s_add_u32 m0, s50, s57
    s_nop 0
    buffer_load_dwordx4 v7, s[24:27], s49 offen offset:0 lds
    buffer_load_dwordx4 v8, s[24:27], s49 offen offset:1024 lds
    buffer_load_dwordx4 v9, s[24:27], s49 offen offset:2048 lds
    buffer_load_dwordx4 v10, s[24:27], s49 offen offset:3072 lds
    s_add_u32 s48, s19, 3
    s_and_b32 s48, s48, 3
    s_lshl_b32 s49, s48, 8
    s_add_u32 s49, s49, s56
    s_lshl_b32 s50, s48, 14
    s_add_u32 m0, s50, s57
    s_nop 0
    buffer_load_dwordx4 v7, s[24:27], s49 offen offset:0 lds
    buffer_load_dwordx4 v8, s[24:27], s49 offen offset:1024 lds
    buffer_load_dwordx4 v9, s[24:27], s49 offen offset:2048 lds
    buffer_load_dwordx4 v10, s[24:27], s49 offen offset:3072 lds
    s_waitcnt vmcnt(14)
    s_barrier
    s_add_u32 s48, s61, 2
    s_and_b32 s48, s48, 7
    s_mul_i32 s60, s48, 196608
    s_add_u32 s60, s60, s58
    s_add_u32 s60, s60, 1024
    s_add_u32 m0, s59, 32768
    s_nop 0
    buffer_load_dwordx4 v11, s[28:31], s60 offen offset:0 lds
    buffer_load_dwordx4 v12, s[28:31], s60 offen offset:1024 lds
    s_add_u32 s60, s60, 1024
    s_add_u32 m0, s59, 40960
    s_nop 0
    buffer_load_dwordx4 v11, s[28:31], s60 offen offset:0 lds
    buffer_load_dwordx4 v12, s[28:31], s60 offen offset:1024 lds
    s_add_u32 s48, s61, 3
    s_and_b32 s48, s48, 7
    s_mul_i32 s60, s48, 196608
    s_add_u32 s60, s60, s58
    s_add_u32 s60, s60, 1024
    s_add_u32 m0, s59, 49152
    s_nop 0
    buffer_load_dwordx4 v11, s[28:31], s60 offen offset:0 lds
    buffer_load_dwordx4 v12, s[28:31], s60 offen offset:1024 lds
    s_add_u32 s60, s60, 1024
    s_add_u32 m0, s59, 57344
    s_nop 0
    buffer_load_dwordx4 v11, s[28:31], s60 offen offset:0 lds
    buffer_load_dwordx4 v12, s[28:31], s60 offen offset:1024 lds
    s_add_u32 s48, s61, 4
    s_and_b32 s48, s48, 7
    s_mul_i32 s60, s48, 196608
    s_add_u32 s60, s60, s58
    s_add_u32 s60, s60, 1024
    s_add_u32 m0, s59, 65536
    s_nop 0
    buffer_load_dwordx4 v11, s[28:31], s60 offen offset:0 lds
    buffer_load_dwordx4 v12, s[28:31], s60 offen offset:1024 lds
    s_add_u32 s60, s60, 1024
    s_add_u32 m0, s59, 73728
    s_nop 0
    buffer_load_dwordx4 v11, s[28:31], s60 offen offset:0 lds
    buffer_load_dwordx4 v12, s[28:31], s60 offen offset:1024 lds
    s_add_u32 s48, s61, 5
    s_and_b32 s48, s48, 7
    s_mul_i32 s60, s48, 196608
    s_add_u32 s60, s60, s58
    s_add_u32 s60, s60, 1024
    s_add_u32 m0, s59, 81920
    s_nop 0
    buffer_load_dwordx4 v11, s[28:31], s60 offen offset:0 lds
    buffer_load_dwordx4 v12, s[28:31], s60 offen offset:1024 lds
    s_add_u32 s60, s60, 1024
    s_add_u32 m0, s59, 90112
    s_nop 0
    buffer_load_dwordx4 v11, s[28:31], s60 offen offset:0 lds
    buffer_load_dwordx4 v12, s[28:31], s60 offen offset:1024 lds
    s_waitcnt vmcnt(12)
    s_barrier
    s_add_u32 s48, s61, 6
    s_and_b32 s48, s48, 7
    s_mul_i32 s60, s48, 196608
    s_add_u32 s60, s60, s58
    s_add_u32 s60, s60, 1024
    s_add_u32 m0, s59, 0
    s_nop 0
    buffer_load_dwordx4 v11, s[28:31], s60 offen offset:0 lds
    buffer_load_dwordx4 v12, s[28:31], s60 offen offset:1024 lds
    s_add_u32 s60, s60, 1024
    s_add_u32 m0, s59, 8192
    s_nop 0
    buffer_load_dwordx4 v11, s[28:31], s60 offen offset:0 lds
    buffer_load_dwordx4 v12, s[28:31], s60 offen offset:1024 lds
    s_lshl_b32 s64, s16, 3
    s_lshl_b32 s65, s21, 1
    s_add_u32 s64, s64, s65
    v_lshrrev_b32 v3, 5, v0
    v_add_u32 v3, s64, v3
    v_and_b32 v4, 7, v0
    v_lshlrev_b32 v4, 1, v4
    v_and_b32 v5, 15, v3
    v_xor_b32 v4, v4, v5
    v_lshlrev_b32 v4, 4, v4
    v_lshl_add_u32 v4, v3, 8, v4
    v_bfe_u32 v5, v0, 3, 2
    v_lshl_add_u32 v4, v5, 14, v4
    v_add_u32 v13, 98304, v4
    v_xor_b32 v14, 16, v13
    v_mov_b32 v56, 0
    v_mov_b32 v57, 0x3f803f80
    v_mov_b32 v40, 0
    v_mov_b32 v48, 0
    v_mov_b32 v41, 0
    v_mov_b32 v49, 0
    v_mov_b32 v42, 0
    v_mov_b32 v50, 0
    v_mov_b32 v43, 0
    v_mov_b32 v51, 0
    v_mov_b32 v44, 0
    v_mov_b32 v52, 0
    v_mov_b32 v45, 0
    v_mov_b32 v53, 0
    v_mov_b32 v46, 0
    v_mov_b32 v54, 0
    v_mov_b32 v47, 0
    v_mov_b32 v55, 0
    s_lshl_b32 s64, s18, 8
    s_add_u32 s64, s64, 9568256
    s_waitcnt vmcnt(12)
    s_barrier
    s_add_u32 s48, s61, 7
    s_and_b32 s48, s48, 7
    s_mul_i32 s60, s48, 196608
    s_add_u32 s60, s60, s58
    s_add_u32 s60, s60, 1024
    s_add_u32 m0, s59, 16384
    s_nop 0
    buffer_load_dwordx4 v11, s[28:31], s60 offen offset:0 lds
    buffer_load_dwordx4 v12, s[28:31], s60 offen offset:1024 lds
    s_add_u32 s60, s60, 1024
    s_add_u32 m0, s59, 24576
    s_nop 0
    buffer_load_dwordx4 v11, s[28:31], s60 offen offset:0 lds
    buffer_load_dwordx4 v12, s[28:31], s60 offen offset:1024 lds
    s_cmp_ge_u32 s68, 528
    s_cbranch_scc1 K1_WISSUED
    buffer_load_dwordx4 v[128:131], v164, s[32:35], 0 offen offset:0
    buffer_load_dwordx4 v[136:139], v164, s[36:39], 0 offen offset:0
    buffer_load_dwordx4 v[132:135], v164, s[32:35], 0 offen offset:16
    buffer_load_dwordx4 v[140:143], v164, s[36:39], 0 offen offset:16
    buffer_load_ushort v160, v163, s[32:35], 0 offen
    buffer_load_ushort v161, v163, s[36:39], 0 offen
K1_WISSUED:
    v_lshlrev_b32 v3, 2, v3
    ds_read_b128 v[24:27], v13
    ds_read_b128 v[28:31], v14
    v_and_b32 v32, 0xffff, v16
    v_and_b32 v16, 0xffff0000, v16
    v_and_b32 v33, 0xffff, v17
    v_and_b32 v17, 0xffff0000, v17
    v_and_b32 v34, 0xffff, v18
    v_and_b32 v18, 0xffff0000, v18
    v_and_b32 v35, 0xffff, v19
    v_and_b32 v19, 0xffff0000, v19
    v_and_b32 v36, 0xffff, v20
    v_and_b32 v20, 0xffff0000, v20
    v_and_b32 v37, 0xffff, v21
    v_and_b32 v21, 0xffff0000, v21
    v_and_b32 v38, 0xffff, v22
    v_and_b32 v22, 0xffff0000, v22
    v_and_b32 v39, 0xffff, v23
    v_and_b32 v23, 0xffff0000, v23
    s_waitcnt lgkmcnt(1)
    v_dot2c_f32_bf16 v40, v24, v32
    v_dot2c_f32_bf16 v48, v24, v16
    v_dot2c_f32_bf16 v41, v25, v33
    v_dot2c_f32_bf16 v49, v25, v17
    v_dot2c_f32_bf16 v42, v26, v34
    v_dot2c_f32_bf16 v50, v26, v18
    v_dot2c_f32_bf16 v43, v27, v35
    v_dot2c_f32_bf16 v51, v27, v19
    s_waitcnt lgkmcnt(0)
    v_dot2c_f32_bf16 v44, v28, v36
    v_dot2c_f32_bf16 v52, v28, v20
    v_dot2c_f32_bf16 v45, v29, v37
    v_dot2c_f32_bf16 v53, v29, v21
    v_dot2c_f32_bf16 v46, v30, v38
    v_dot2c_f32_bf16 v54, v30, v22
    v_dot2c_f32_bf16 v47, v31, v39
    v_dot2c_f32_bf16 v55, v31, v23
    s_cmp_ge_u32 s68, 528
    s_cbranch_scc1 K1_S2A_c4
    s_waitcnt vmcnt(18)
    s_branch K1_S2B_c4
K1_S2A_c4:
    s_waitcnt vmcnt(12)
K1_S2B_c4:
    s_barrier
    v_cvt_pk_bf16_f32 v40, v40, v48
    v_cvt_pk_bf16_f32 v41, v41, v49
    v_cvt_pk_bf16_f32 v42, v42, v50
    v_cvt_pk_bf16_f32 v43, v43, v51
    v_cvt_pk_bf16_f32 v44, v44, v52
    v_cvt_pk_bf16_f32 v45, v45, v53
    v_cvt_pk_bf16_f32 v46, v46, v54
    v_cvt_pk_bf16_f32 v47, v47, v55
    v_dot2c_f32_bf16 v56, v40, v57
    v_dot2c_f32_bf16 v56, v41, v57
    v_dot2c_f32_bf16 v56, v42, v57
    v_dot2c_f32_bf16 v56, v43, v57
    v_dot2c_f32_bf16 v56, v44, v57
    v_dot2c_f32_bf16 v56, v45, v57
    v_dot2c_f32_bf16 v56, v46, v57
    v_dot2c_f32_bf16 v56, v47, v57
    s_nop 2
    v_add_f32_dpp v56, v56, v56 row_ror:8 row_mask:0xf bank_mask:0xf
    s_nop 1
    v_add_f32_dpp v56, v56, v56 row_ror:4 row_mask:0xf bank_mask:0xf
    s_nop 1
    v_add_f32_dpp v56, v56, v56 row_ror:2 row_mask:0xf bank_mask:0xf
    s_nop 1
    v_add_f32_dpp v56, v56, v56 row_ror:1 row_mask:0xf bank_mask:0xf
    v_mov_b32 v4, v56
    s_nop 1
    v_permlane16_swap_b32 v56, v4
    v_add_f32 v56, v56, v4
    v_cvt_pk_bf16_f32 v56, v56, v56
    v_lshlrev_b32 v56, 16, v56
    v_mul_f32 v56, 0xbfb8aa3b, v56
    v_exp_f32 v56, v56
    s_nop 0
    v_add_f32 v56, 1.0, v56
    v_rcp_f32 v56, v56
    s_nop 0
    v_cvt_pk_bf16_f32 v56, v56, v56
    v_lshlrev_b32 v56, 16, v56
    s_mov_b32 s66, 1
    s_mov_b32 s67, 1
    s_cmp_ge_u32 s68, 528
    s_cbranch_scc1 K1_S2A_c5
    s_waitcnt vmcnt(14)
    s_branch K1_S2B_c5
K1_S2A_c5:
    s_waitcnt vmcnt(8)
K1_S2B_c5:
    s_barrier
    s_cmp_ge_u32 s68, 528
    s_cbranch_scc1 K1_S2A_c6
    s_waitcnt vmcnt(10)
    s_branch K1_S2B_c6
K1_S2A_c6:
    s_waitcnt vmcnt(4)
K1_S2B_c6:
    s_barrier
    s_cmp_ge_u32 s68, 528
    s_cbranch_scc1 K1_S2A_c7
    s_waitcnt vmcnt(6)
    s_branch K1_S2B_c7
K1_S2A_c7:
    s_waitcnt vmcnt(0)
K1_S2B_c7:
    s_barrier
    s_mov_b64 exec, s[66:67]
    buffer_store_dword v56, v3, s[44:47], s64 offen
    s_mov_b64 exec, -1
    s_waitcnt vmcnt(1)
    s_cmp_ge_u32 s68, 528
    s_cbranch_scc1 K1_WDONE
    v_lshlrev_b32 v165, 11, v1
    v_lshl_add_u32 v165, v2, 4, v165
    s_mov_b32 s72, 0x05040100
    s_mov_b32 s73, 0x07060302
    s_mov_b32 s74, 0x00010001
    s_mov_b32 s75, 0x00010001
    s_bitcmp1_b32 s68, 0
    s_cbranch_scc1 K1_WMIR
    v_perm_b32 v144, v136, v128, s72
    v_perm_b32 v148, v136, v128, s73
    v_perm_b32 v152, v137, v129, s72
    v_perm_b32 v156, v137, v129, s73
    v_perm_b32 v145, v138, v130, s72
    v_perm_b32 v149, v138, v130, s73
    v_perm_b32 v153, v139, v131, s72
    v_perm_b32 v157, v139, v131, s73
    v_perm_b32 v146, v140, v132, s72
    v_perm_b32 v150, v140, v132, s73
    v_perm_b32 v154, v141, v133, s72
    v_perm_b32 v158, v141, v133, s73
    v_perm_b32 v147, v142, v134, s72
    v_perm_b32 v151, v142, v134, s73
    v_perm_b32 v155, v143, v135, s72
    v_perm_b32 v159, v143, v135, s73
    s_mov_b64 exec, s[74:75]
    v_lshlrev_b32 v162, 16, v144
    v_and_b32 v163, 0xffff0000, v144
    v_lshlrev_b32 v160, 16, v160
    v_lshlrev_b32 v161, 16, v161
    v_add_f32 v162, v162, v160
    v_sub_f32 v163, v163, v161
    v_mul_f32 v162, 0.5, v162
    v_mul_f32 v163, 0.5, v163
    v_cvt_pk_bf16_f32 v144, v162, v163
    s_mov_b64 exec, -1
    buffer_store_dwordx4 v[144:147], v165, s[44:47], s69 offen offset:0 sc1
    buffer_store_dwordx4 v[148:151], v165, s[44:47], s69 offen offset:512 sc1
    buffer_store_dwordx4 v[152:155], v165, s[44:47], s69 offen offset:1024 sc1
    buffer_store_dwordx4 v[156:159], v165, s[44:47], s69 offen offset:1536 sc1
    s_nop 1
    s_branch K1_WDONE
K1_WMIR:
    v_xor_b32 v136, 0x80008000, v136
    v_xor_b32 v137, 0x80008000, v137
    v_xor_b32 v138, 0x80008000, v138
    v_xor_b32 v139, 0x80008000, v139
    v_xor_b32 v140, 0x80008000, v140
    v_xor_b32 v141, 0x80008000, v141
    v_xor_b32 v142, 0x80008000, v142
    v_xor_b32 v143, 0x80008000, v143
    v_perm_b32 v144, v143, v135, s73
    v_perm_b32 v148, v143, v135, s72
    v_perm_b32 v152, v142, v134, s73
    v_perm_b32 v156, v142, v134, s72
    v_perm_b32 v145, v141, v133, s73
    v_perm_b32 v149, v141, v133, s72
    v_perm_b32 v153, v140, v132, s73
    v_perm_b32 v157, v140, v132, s72
    v_perm_b32 v146, v139, v131, s73
    v_perm_b32 v150, v139, v131, s72
    v_perm_b32 v154, v138, v130, s73
    v_perm_b32 v158, v138, v130, s72
    v_perm_b32 v147, v137, v129, s73
    v_perm_b32 v151, v137, v129, s72
    v_perm_b32 v155, v136, v128, s73
    v_perm_b32 v159, v136, v128, s72
    s_mov_b64 exec, s[74:75]
    v_lshlrev_b32 v162, 16, v144
    v_and_b32 v163, 0xffff0000, v144
    v_lshlrev_b32 v160, 16, v160
    v_lshlrev_b32 v161, 16, v161
    v_add_f32 v162, v162, v160
    v_add_f32 v163, v163, v161
    v_mul_f32 v162, 0.5, v162
    v_mul_f32 v163, 0.5, v163
    v_cvt_pk_bf16_f32 v144, v162, v163
    s_mov_b64 exec, -1
    buffer_store_dwordx4 v[144:147], v165, s[44:47], s69 offen offset:256 sc1
    buffer_store_dwordx4 v[148:151], v165, s[44:47], s69 offen offset:768 sc1
    buffer_store_dwordx4 v[152:155], v165, s[44:47], s69 offen offset:1280 sc1
    buffer_store_dwordx4 v[156:159], v165, s[44:47], s69 offen offset:1792 sc1
    s_nop 1
K1_WDONE:
    s_lshr_b32 s48, s2, 3
    v_lshlrev_b32 v5, 4, v0
    s_lshl_b32 s49, s48, 2
    s_add_u32 s49, s49, s21
    s_cmp_ge_u32 s49, (GM_CODE_END - gm_k2_kernel) / 1024
    s_cbranch_scc1 K1_NOCODE
    s_getpc_b64 s[50:51]
K1_PC:
    s_lshl_b32 s49, s49, 10
    s_add_u32 s49, s49, gm_k2_kernel - K1_PC
    s_add_u32 s50, s50, s49
    s_addc_u32 s51, s51, 0
    global_load_dwordx4 v[108:111], v5, s[50:51]
K1_NOCODE:
    s_endpgm
K1_NOTL:
    s_cmp_ge_u32 s20, 4
    s_cbranch_scc1 K1_FFT
    s_waitcnt lgkmcnt(0)
    s_mov_b32 s44, s14
    s_mov_b32 s45, s15
    s_mov_b32 s46, 0x1400000
    s_mov_b32 s47, 0x00020000
    s_sub_u32 s49, s2, 32
    s_lshl_b32 s48, s20, 4
    s_and_b32 s48, s48, 32
    s_or_b32 s48, s48, s49
    s_cmp_ge_u32 s48, 32
    s_cbranch_scc1 K1_NOWO3
    s_load_dwordx2 s[50:51], s[0:1], 16
    s_and_b32 s48, s49, 7
    s_lshr_b32 s52, s49, 4
    s_lshl_b32 s52, s52, 3
    s_add_u32 s48, s48, s52
    s_lshl_b32 s48, s48, 1
    s_bfe_u32 s52, s49, 0x10003
    s_add_u32 s48, s48, s52
    s_lshl_b32 s48, s48, 14
    s_lshl_b32 s52, s20, 13
    s_add_u32 s48, s48, s52
    v_lshlrev_b32 v4, 7, v0
    s_waitcnt lgkmcnt(0)
    s_mov_b32 s72, s50
    s_mov_b32 s73, s51
    s_mov_b32 s74, 0x80000
    s_mov_b32 s75, 0x00020000
    buffer_load_dword v22, v4, s[72:75], s48 offen sc1
K1_NOWO3:
    s_cmp_lg_u32 s20, 2
    s_cbranch_scc1 K1_NOWQ2
    s_mov_b32 s28, s6
    s_mov_b32 s29, s7
    s_mov_b32 s30, 0x180000
    s_mov_b32 s31, 0x00020000
    s_lshr_b32 s48, s2, 3
    s_mul_i32 s48, s48, 49152
    s_and_b32 s49, s2, 1
    s_lshl_b32 s49, s49, 9
    s_add_u32 s48, s48, s49
    v_lshrrev_b32 v4, 2, v0
    v_mul_u32_u24 v4, 3072, v4
    v_and_b32 v5, 3, v0
    v_lshl_add_u32 v4, v5, 7, v4
    buffer_load_dword v22, v4, s[28:31], s48 offen sc1
K1_NOWQ2:
    s_lshl_b32 s48, s19, 14
    s_add_u32 s48, s48, 98304
    v_lshl_add_u32 v4, v2, 8, s48
    v_xor_b32 v5, v1, v2
    v_lshl_add_u32 v24, v5, 4, v4
    v_xor_b32 v25, 64, v24
    v_xor_b32 v26, 128, v24
    v_xor_b32 v27, 192, v24
    v_bfe_u32 v4, v0, 2, 2
    v_bfe_u32 v5, v0, 3, 1
    v_and_b32 v6, 1, v1
    v_lshl_or_b32 v5, v6, 1, v5
    v_xor_b32 v5, s20, v5
    v_lshl_add_u32 v4, v1, 3, v4
    v_lshlrev_b32 v4, 7, v4
    v_lshl_add_u32 v4, v5, 5, v4
    v_and_b32 v5, 3, v0
    v_lshl_add_u32 v28, v5, 3, v4
    v_add_u32 v32, 49152, v28
    v_mov_b32 v16, 0x3f803f80
    v_mov_b32 v17, 0x3f803f80
    v_mov_b32 v18, 0x3f803f80
    v_mov_b32 v19, 0x3f803f80
    v_mov_b32 v29, 0x3fb8aa3b
    s_lshl_b32 s48, s16, 2
    s_add_u32 s48, s48, s20
    s_lshl_b32 s52, s48, 15
    s_lshl_b32 s50, s18, 10
    s_add_u32 s52, s52, s50
    s_add_u32 s52, s52, 8388608
    s_lshl_b32 s51, s48, 11
    s_lshl_b32 s50, s18, 6
    s_add_u32 s51, s51, s50
    s_add_u32 s51, s51, 9437184
    s_lshl_b32 s53, s18, 16
    s_lshl_b32 s50, s48, 9
    s_add_u32 s53, s53, s50
    s_add_u32 s53, s53, 2621440
    v_lshlrev_b32 v3, 4, v0
    v_lshlrev_b32 v30, 2, v2
    v_lshlrev_b32 v31, 3, v0
    s_barrier
    ds_read_b64_tr_b16 v[116:117], v28 offset:0
    ds_read_b64_tr_b16 v[118:119], v28 offset:512
    ds_read_b64_tr_b16 v[120:121], v28 offset:8192
    ds_read_b64_tr_b16 v[122:123], v28 offset:8704
    ds_read_b128 v[68:71], v24 offset:0
    ds_read_b128 v[72:75], v24 offset:4096
    ds_read_b128 v[76:79], v24 offset:8192
    ds_read_b128 v[80:83], v24 offset:12288
    ds_read_b64_tr_b16 v[124:125], v28 offset:4096
    ds_read_b64_tr_b16 v[126:127], v28 offset:4608
    ds_read_b64_tr_b16 v[128:129], v28 offset:12288
    ds_read_b64_tr_b16 v[130:131], v28 offset:12800
    s_waitcnt lgkmcnt(7)
    v_mfma_f32_16x16x32_bf16 v[36:39], v[68:71], v[116:119], 0
    ds_read_b128 v[84:87], v25 offset:0
    v_mfma_f32_16x16x32_bf16 v[40:43], v[68:71], v[120:123], 0
    ds_read_b128 v[88:91], v25 offset:4096
    s_waitcnt lgkmcnt(8)
    v_mfma_f32_16x16x32_bf16 v[44:47], v[72:75], v[116:119], 0
    ds_read_b128 v[92:95], v25 offset:8192
    v_mfma_f32_16x16x32_bf16 v[48:51], v[72:75], v[120:123], 0
    ds_read_b128 v[96:99], v25 offset:12288
    s_waitcnt lgkmcnt(9)
    v_mfma_f32_16x16x32_bf16 v[52:55], v[76:79], v[116:119], 0
    v_mfma_f32_16x16x32_bf16 v[56:59], v[76:79], v[120:123], 0
    s_waitcnt lgkmcnt(8)
    v_mfma_f32_16x16x32_bf16 v[60:63], v[80:83], v[116:119], 0
    v_mfma_f32_16x16x32_bf16 v[64:67], v[80:83], v[120:123], 0
    s_waitcnt lgkmcnt(0)
    s_barrier
    v_mfma_f32_16x16x32_bf16 v[36:39], v[84:87], v[124:127], v[36:39]
    ds_read_b64_tr_b16 v[132:133], v28 offset:16384
    ds_read_b64_tr_b16 v[134:135], v28 offset:16896
    v_mfma_f32_16x16x32_bf16 v[40:43], v[84:87], v[128:131], v[40:43]
    ds_read_b64_tr_b16 v[136:137], v28 offset:24576
    ds_read_b64_tr_b16 v[138:139], v28 offset:25088
    v_mfma_f32_16x16x32_bf16 v[44:47], v[88:91], v[124:127], v[44:47]
    ds_read_b128 v[100:103], v26 offset:0
    ds_read_b128 v[104:107], v26 offset:4096
    v_mfma_f32_16x16x32_bf16 v[48:51], v[88:91], v[128:131], v[48:51]
    ds_read_b128 v[108:111], v26 offset:8192
    ds_read_b128 v[112:115], v26 offset:12288
    v_mfma_f32_16x16x32_bf16 v[52:55], v[92:95], v[124:127], v[52:55]
    ds_read_b64_tr_b16 v[116:117], v28 offset:20480
    ds_read_b64_tr_b16 v[118:119], v28 offset:20992
    v_mfma_f32_16x16x32_bf16 v[56:59], v[92:95], v[128:131], v[56:59]
    ds_read_b64_tr_b16 v[120:121], v28 offset:28672
    ds_read_b64_tr_b16 v[122:123], v28 offset:29184
    v_mfma_f32_16x16x32_bf16 v[60:63], v[96:99], v[124:127], v[60:63]
    v_mfma_f32_16x16x32_bf16 v[64:67], v[96:99], v[128:131], v[64:67]
    s_waitcnt lgkmcnt(7)
    v_mfma_f32_16x16x32_bf16 v[36:39], v[100:103], v[132:135], v[36:39]
    ds_read_b128 v[68:71], v27 offset:0
    v_mfma_f32_16x16x32_bf16 v[40:43], v[100:103], v[136:139], v[40:43]
    ds_read_b128 v[72:75], v27 offset:4096
    s_waitcnt lgkmcnt(8)
    v_mfma_f32_16x16x32_bf16 v[44:47], v[104:107], v[132:135], v[44:47]
    ds_read_b128 v[76:79], v27 offset:8192
    v_mfma_f32_16x16x32_bf16 v[48:51], v[104:107], v[136:139], v[48:51]
    ds_read_b128 v[80:83], v27 offset:12288
    s_waitcnt lgkmcnt(9)
    v_mfma_f32_16x16x32_bf16 v[52:55], v[108:111], v[132:135], v[52:55]
    v_mfma_f32_16x16x32_bf16 v[56:59], v[108:111], v[136:139], v[56:59]
    s_waitcnt lgkmcnt(8)
    v_mfma_f32_16x16x32_bf16 v[60:63], v[112:115], v[132:135], v[60:63]
    v_mfma_f32_16x16x32_bf16 v[64:67], v[112:115], v[136:139], v[64:67]
    s_add_u32 s48, s19, 1
    s_and_b32 s48, s48, 3
    s_cmp_eq_u32 s48, 0
    s_movk_i32 s49, 16384
    s_cselect_b32 s48, 0xffff4000, s49
    v_add_u32 v24, s48, v24
    v_add_u32 v25, s48, v25
    v_add_u32 v26, s48, v26
    v_add_u32 v27, s48, v27
    s_waitcnt lgkmcnt(0)
    s_barrier
    v_mfma_f32_16x16x32_bf16 v[36:39], v[68:71], v[116:119], v[36:39]
    ds_read_b64_tr_b16 v[124:125], v28 offset:32768
    ds_read_b64_tr_b16 v[126:127], v28 offset:33280
    v_mfma_f32_16x16x32_bf16 v[40:43], v[68:71], v[120:123], v[40:43]
    ds_read_b64_tr_b16 v[128:129], v28 offset:40960
    ds_read_b64_tr_b16 v[130:131], v28 offset:41472
    v_mfma_f32_16x16x32_bf16 v[44:47], v[72:75], v[116:119], v[44:47]
    ds_read_b128 v[84:87], v24 offset:0
    ds_read_b128 v[88:91], v24 offset:4096
    v_mfma_f32_16x16x32_bf16 v[48:51], v[72:75], v[120:123], v[48:51]
    ds_read_b128 v[92:95], v24 offset:8192
    ds_read_b128 v[96:99], v24 offset:12288
    v_mfma_f32_16x16x32_bf16 v[52:55], v[76:79], v[116:119], v[52:55]
    ds_read_b64_tr_b16 v[132:133], v28 offset:36864
    ds_read_b64_tr_b16 v[134:135], v28 offset:37376
    v_mfma_f32_16x16x32_bf16 v[56:59], v[76:79], v[120:123], v[56:59]
    ds_read_b64_tr_b16 v[136:137], v28 offset:45056
    ds_read_b64_tr_b16 v[138:139], v28 offset:45568
    v_mfma_f32_16x16x32_bf16 v[60:63], v[80:83], v[116:119], v[60:63]
    v_mfma_f32_16x16x32_bf16 v[64:67], v[80:83], v[120:123], v[64:67]
    s_waitcnt lgkmcnt(7)
    v_mfma_f32_16x16x32_bf16 v[36:39], v[84:87], v[124:127], v[36:39]
    ds_read_b128 v[100:103], v25 offset:0
    v_mfma_f32_16x16x32_bf16 v[40:43], v[84:87], v[128:131], v[40:43]
    ds_read_b128 v[104:107], v25 offset:4096
    s_waitcnt lgkmcnt(8)
    v_mfma_f32_16x16x32_bf16 v[44:47], v[88:91], v[124:127], v[44:47]
    ds_read_b128 v[108:111], v25 offset:8192
    v_mfma_f32_16x16x32_bf16 v[48:51], v[88:91], v[128:131], v[48:51]
    ds_read_b128 v[112:115], v25 offset:12288
    s_waitcnt lgkmcnt(9)
    v_mfma_f32_16x16x32_bf16 v[52:55], v[92:95], v[124:127], v[52:55]
    v_mfma_f32_16x16x32_bf16 v[56:59], v[92:95], v[128:131], v[56:59]
    s_waitcnt lgkmcnt(8)
    v_mfma_f32_16x16x32_bf16 v[60:63], v[96:99], v[124:127], v[60:63]
    v_mfma_f32_16x16x32_bf16 v[64:67], v[96:99], v[128:131], v[64:67]
    s_waitcnt lgkmcnt(0)
    s_barrier
    v_mfma_f32_16x16x32_bf16 v[36:39], v[100:103], v[132:135], v[36:39]
    ds_read_b64_tr_b16 v[116:117], v32 offset:0
    ds_read_b64_tr_b16 v[118:119], v32 offset:512
    v_mfma_f32_16x16x32_bf16 v[40:43], v[100:103], v[136:139], v[40:43]
    ds_read_b64_tr_b16 v[120:121], v32 offset:8192
    ds_read_b64_tr_b16 v[122:123], v32 offset:8704
    v_mfma_f32_16x16x32_bf16 v[44:47], v[104:107], v[132:135], v[44:47]
    ds_read_b128 v[68:71], v26 offset:0
    ds_read_b128 v[72:75], v26 offset:4096
    v_mfma_f32_16x16x32_bf16 v[48:51], v[104:107], v[136:139], v[48:51]
    ds_read_b128 v[76:79], v26 offset:8192
    ds_read_b128 v[80:83], v26 offset:12288
    v_mfma_f32_16x16x32_bf16 v[52:55], v[108:111], v[132:135], v[52:55]
    ds_read_b64_tr_b16 v[124:125], v32 offset:4096
    ds_read_b64_tr_b16 v[126:127], v32 offset:4608
    v_mfma_f32_16x16x32_bf16 v[56:59], v[108:111], v[136:139], v[56:59]
    ds_read_b64_tr_b16 v[128:129], v32 offset:12288
    ds_read_b64_tr_b16 v[130:131], v32 offset:12800
    v_mfma_f32_16x16x32_bf16 v[60:63], v[112:115], v[132:135], v[60:63]
    v_mfma_f32_16x16x32_bf16 v[64:67], v[112:115], v[136:139], v[64:67]
    s_waitcnt lgkmcnt(7)
    v_mfma_f32_16x16x32_bf16 v[36:39], v[68:71], v[116:119], v[36:39]
    ds_read_b128 v[84:87], v27 offset:0
    v_mfma_f32_16x16x32_bf16 v[40:43], v[68:71], v[120:123], v[40:43]
    ds_read_b128 v[88:91], v27 offset:4096
    s_waitcnt lgkmcnt(8)
    v_mfma_f32_16x16x32_bf16 v[44:47], v[72:75], v[116:119], v[44:47]
    ds_read_b128 v[92:95], v27 offset:8192
    v_mfma_f32_16x16x32_bf16 v[48:51], v[72:75], v[120:123], v[48:51]
    ds_read_b128 v[96:99], v27 offset:12288
    s_waitcnt lgkmcnt(9)
    v_mfma_f32_16x16x32_bf16 v[52:55], v[76:79], v[116:119], v[52:55]
    v_mfma_f32_16x16x32_bf16 v[56:59], v[76:79], v[120:123], v[56:59]
    s_waitcnt lgkmcnt(8)
    v_mfma_f32_16x16x32_bf16 v[60:63], v[80:83], v[116:119], v[60:63]
    v_mfma_f32_16x16x32_bf16 v[64:67], v[80:83], v[120:123], v[64:67]
    s_add_u32 s48, s19, 2
    s_and_b32 s48, s48, 3
    s_cmp_eq_u32 s48, 0
    s_movk_i32 s49, 16384
    s_cselect_b32 s48, 0xffff4000, s49
    v_add_u32 v24, s48, v24
    v_add_u32 v25, s48, v25
    v_add_u32 v26, s48, v26
    v_add_u32 v27, s48, v27
    s_waitcnt lgkmcnt(0)
    s_barrier
    v_mfma_f32_16x16x32_bf16 v[36:39], v[84:87], v[124:127], v[36:39]
    ds_read_b64_tr_b16 v[132:133], v32 offset:16384
    ds_read_b64_tr_b16 v[134:135], v32 offset:16896
    v_mfma_f32_16x16x32_bf16 v[40:43], v[84:87], v[128:131], v[40:43]
    ds_read_b64_tr_b16 v[136:137], v32 offset:24576
    ds_read_b64_tr_b16 v[138:139], v32 offset:25088
    v_mfma_f32_16x16x32_bf16 v[44:47], v[88:91], v[124:127], v[44:47]
    ds_read_b128 v[100:103], v24 offset:0
    ds_read_b128 v[104:107], v24 offset:4096
    v_mfma_f32_16x16x32_bf16 v[48:51], v[88:91], v[128:131], v[48:51]
    ds_read_b128 v[108:111], v24 offset:8192
    ds_read_b128 v[112:115], v24 offset:12288
    v_mfma_f32_16x16x32_bf16 v[52:55], v[92:95], v[124:127], v[52:55]
    ds_read_b64_tr_b16 v[116:117], v32 offset:20480
    ds_read_b64_tr_b16 v[118:119], v32 offset:20992
    v_mfma_f32_16x16x32_bf16 v[56:59], v[92:95], v[128:131], v[56:59]
    ds_read_b64_tr_b16 v[120:121], v32 offset:28672
    ds_read_b64_tr_b16 v[122:123], v32 offset:29184
    v_mfma_f32_16x16x32_bf16 v[60:63], v[96:99], v[124:127], v[60:63]
    v_mfma_f32_16x16x32_bf16 v[64:67], v[96:99], v[128:131], v[64:67]
    s_waitcnt lgkmcnt(7)
    v_mfma_f32_16x16x32_bf16 v[36:39], v[100:103], v[132:135], v[36:39]
    ds_read_b128 v[68:71], v25 offset:0
    v_mfma_f32_16x16x32_bf16 v[40:43], v[100:103], v[136:139], v[40:43]
    ds_read_b128 v[72:75], v25 offset:4096
    s_waitcnt lgkmcnt(8)
    v_mfma_f32_16x16x32_bf16 v[44:47], v[104:107], v[132:135], v[44:47]
    ds_read_b128 v[76:79], v25 offset:8192
    v_mfma_f32_16x16x32_bf16 v[48:51], v[104:107], v[136:139], v[48:51]
    ds_read_b128 v[80:83], v25 offset:12288
    s_waitcnt lgkmcnt(9)
    v_mfma_f32_16x16x32_bf16 v[52:55], v[108:111], v[132:135], v[52:55]
    v_mfma_f32_16x16x32_bf16 v[56:59], v[108:111], v[136:139], v[56:59]
    s_waitcnt lgkmcnt(8)
    v_mfma_f32_16x16x32_bf16 v[60:63], v[112:115], v[132:135], v[60:63]
    v_mfma_f32_16x16x32_bf16 v[64:67], v[112:115], v[136:139], v[64:67]
    s_waitcnt lgkmcnt(0)
    s_barrier
    v_mfma_f32_16x16x32_bf16 v[36:39], v[68:71], v[116:119], v[36:39]
    ds_read_b64_tr_b16 v[124:125], v32 offset:32768
    ds_read_b64_tr_b16 v[126:127], v32 offset:33280
    v_mfma_f32_16x16x32_bf16 v[40:43], v[68:71], v[120:123], v[40:43]
    ds_read_b64_tr_b16 v[128:129], v32 offset:40960
    ds_read_b64_tr_b16 v[130:131], v32 offset:41472
    v_mfma_f32_16x16x32_bf16 v[44:47], v[72:75], v[116:119], v[44:47]
    ds_read_b128 v[84:87], v26 offset:0
    ds_read_b128 v[88:91], v26 offset:4096
    v_mfma_f32_16x16x32_bf16 v[48:51], v[72:75], v[120:123], v[48:51]
    ds_read_b128 v[92:95], v26 offset:8192
    ds_read_b128 v[96:99], v26 offset:12288
    v_mfma_f32_16x16x32_bf16 v[52:55], v[76:79], v[116:119], v[52:55]
    ds_read_b64_tr_b16 v[132:133], v32 offset:36864
    ds_read_b64_tr_b16 v[134:135], v32 offset:37376
    v_mfma_f32_16x16x32_bf16 v[56:59], v[76:79], v[120:123], v[56:59]
    ds_read_b64_tr_b16 v[136:137], v32 offset:45056
    ds_read_b64_tr_b16 v[138:139], v32 offset:45568
    v_mfma_f32_16x16x32_bf16 v[60:63], v[80:83], v[116:119], v[60:63]
    v_mfma_f32_16x16x32_bf16 v[64:67], v[80:83], v[120:123], v[64:67]
    s_waitcnt lgkmcnt(7)
    v_mfma_f32_16x16x32_bf16 v[36:39], v[84:87], v[124:127], v[36:39]
    ds_read_b128 v[100:103], v27 offset:0
    v_mfma_f32_16x16x32_bf16 v[40:43], v[84:87], v[128:131], v[40:43]
    ds_read_b128 v[104:107], v27 offset:4096
    s_waitcnt lgkmcnt(8)
    v_mfma_f32_16x16x32_bf16 v[44:47], v[88:91], v[124:127], v[44:47]
    ds_read_b128 v[108:111], v27 offset:8192
    v_mfma_f32_16x16x32_bf16 v[48:51], v[88:91], v[128:131], v[48:51]
    ds_read_b128 v[112:115], v27 offset:12288
    s_waitcnt lgkmcnt(9)
    v_mfma_f32_16x16x32_bf16 v[52:55], v[92:95], v[124:127], v[52:55]
    v_mfma_f32_16x16x32_bf16 v[56:59], v[92:95], v[128:131], v[56:59]
    s_waitcnt lgkmcnt(8)
    v_mfma_f32_16x16x32_bf16 v[60:63], v[96:99], v[124:127], v[60:63]
    v_mfma_f32_16x16x32_bf16 v[64:67], v[96:99], v[128:131], v[64:67]
    s_add_u32 s48, s19, 3
    s_and_b32 s48, s48, 3
    s_cmp_eq_u32 s48, 0
    s_movk_i32 s49, 16384
    s_cselect_b32 s48, 0xffff4000, s49
    v_add_u32 v24, s48, v24
    v_add_u32 v25, s48, v25
    v_add_u32 v26, s48, v26
    v_add_u32 v27, s48, v27
    s_waitcnt lgkmcnt(0)
    s_barrier
    v_mfma_f32_16x16x32_bf16 v[36:39], v[100:103], v[132:135], v[36:39]
    ds_read_b64_tr_b16 v[116:117], v28 offset:0
    ds_read_b64_tr_b16 v[118:119], v28 offset:512
    v_mfma_f32_16x16x32_bf16 v[40:43], v[100:103], v[136:139], v[40:43]
    ds_read_b64_tr_b16 v[120:121], v28 offset:8192
    ds_read_b64_tr_b16 v[122:123], v28 offset:8704
    v_mfma_f32_16x16x32_bf16 v[44:47], v[104:107], v[132:135], v[44:47]
    ds_read_b128 v[68:71], v24 offset:0
    ds_read_b128 v[72:75], v24 offset:4096
    v_mfma_f32_16x16x32_bf16 v[48:51], v[104:107], v[136:139], v[48:51]
    ds_read_b128 v[76:79], v24 offset:8192
    ds_read_b128 v[80:83], v24 offset:12288
    v_mfma_f32_16x16x32_bf16 v[52:55], v[108:111], v[132:135], v[52:55]
    ds_read_b64_tr_b16 v[124:125], v28 offset:4096
    ds_read_b64_tr_b16 v[126:127], v28 offset:4608
    v_mfma_f32_16x16x32_bf16 v[56:59], v[108:111], v[136:139], v[56:59]
    ds_read_b64_tr_b16 v[128:129], v28 offset:12288
    ds_read_b64_tr_b16 v[130:131], v28 offset:12800
    v_mfma_f32_16x16x32_bf16 v[60:63], v[112:115], v[132:135], v[60:63]
    v_mfma_f32_16x16x32_bf16 v[64:67], v[112:115], v[136:139], v[64:67]
    s_waitcnt lgkmcnt(7)
    v_mfma_f32_16x16x32_bf16 v[36:39], v[68:71], v[116:119], v[36:39]
    ds_read_b128 v[84:87], v25 offset:0
    v_mfma_f32_16x16x32_bf16 v[40:43], v[68:71], v[120:123], v[40:43]
    ds_read_b128 v[88:91], v25 offset:4096
    s_waitcnt lgkmcnt(8)
    v_mfma_f32_16x16x32_bf16 v[44:47], v[72:75], v[116:119], v[44:47]
    ds_read_b128 v[92:95], v25 offset:8192
    v_mfma_f32_16x16x32_bf16 v[48:51], v[72:75], v[120:123], v[48:51]
    ds_read_b128 v[96:99], v25 offset:12288
    s_waitcnt lgkmcnt(9)
    v_mfma_f32_16x16x32_bf16 v[52:55], v[76:79], v[116:119], v[52:55]
    v_mfma_f32_16x16x32_bf16 v[56:59], v[76:79], v[120:123], v[56:59]
    s_waitcnt lgkmcnt(8)
    v_mfma_f32_16x16x32_bf16 v[60:63], v[80:83], v[116:119], v[60:63]
    v_mfma_f32_16x16x32_bf16 v[64:67], v[80:83], v[120:123], v[64:67]
    s_waitcnt lgkmcnt(0)
    s_barrier
    v_mfma_f32_16x16x32_bf16 v[36:39], v[84:87], v[124:127], v[36:39]
    ds_read_b64_tr_b16 v[132:133], v28 offset:16384
    ds_read_b64_tr_b16 v[134:135], v28 offset:16896
    v_mfma_f32_16x16x32_bf16 v[40:43], v[84:87], v[128:131], v[40:43]
    ds_read_b64_tr_b16 v[136:137], v28 offset:24576
    ds_read_b64_tr_b16 v[138:139], v28 offset:25088
    v_mfma_f32_16x16x32_bf16 v[44:47], v[88:91], v[124:127], v[44:47]
    ds_read_b128 v[100:103], v26 offset:0
    ds_read_b128 v[104:107], v26 offset:4096
    v_mfma_f32_16x16x32_bf16 v[48:51], v[88:91], v[128:131], v[48:51]
    ds_read_b128 v[108:111], v26 offset:8192
    ds_read_b128 v[112:115], v26 offset:12288
    v_mfma_f32_16x16x32_bf16 v[52:55], v[92:95], v[124:127], v[52:55]
    ds_read_b64_tr_b16 v[116:117], v28 offset:20480
    ds_read_b64_tr_b16 v[118:119], v28 offset:20992
    v_mfma_f32_16x16x32_bf16 v[56:59], v[92:95], v[128:131], v[56:59]
    ds_read_b64_tr_b16 v[120:121], v28 offset:28672
    ds_read_b64_tr_b16 v[122:123], v28 offset:29184
    v_mfma_f32_16x16x32_bf16 v[60:63], v[96:99], v[124:127], v[60:63]
    v_mfma_f32_16x16x32_bf16 v[64:67], v[96:99], v[128:131], v[64:67]
    s_waitcnt lgkmcnt(7)
    v_mfma_f32_16x16x32_bf16 v[36:39], v[100:103], v[132:135], v[36:39]
    ds_read_b128 v[68:71], v27 offset:0
    v_mfma_f32_16x16x32_bf16 v[40:43], v[100:103], v[136:139], v[40:43]
    ds_read_b128 v[72:75], v27 offset:4096
    s_waitcnt lgkmcnt(8)
    v_mfma_f32_16x16x32_bf16 v[44:47], v[104:107], v[132:135], v[44:47]
    ds_read_b128 v[76:79], v27 offset:8192
    v_mfma_f32_16x16x32_bf16 v[48:51], v[104:107], v[136:139], v[48:51]
    ds_read_b128 v[80:83], v27 offset:12288
    s_waitcnt lgkmcnt(9)
    v_mfma_f32_16x16x32_bf16 v[52:55], v[108:111], v[132:135], v[52:55]
    v_mfma_f32_16x16x32_bf16 v[56:59], v[108:111], v[136:139], v[56:59]
    s_waitcnt lgkmcnt(8)
    v_mfma_f32_16x16x32_bf16 v[60:63], v[112:115], v[132:135], v[60:63]
    v_mfma_f32_16x16x32_bf16 v[64:67], v[112:115], v[136:139], v[64:67]
    s_waitcnt lgkmcnt(3)
    v_mfma_f32_16x16x32_bf16 v[36:39], v[68:71], v[116:119], v[36:39]
    v_mfma_f32_16x16x32_bf16 v[40:43], v[68:71], v[120:123], v[40:43]
    s_waitcnt lgkmcnt(2)
    v_mfma_f32_16x16x32_bf16 v[44:47], v[72:75], v[116:119], v[44:47]
    v_mfma_f32_16x16x32_bf16 v[48:51], v[72:75], v[120:123], v[48:51]
    s_waitcnt lgkmcnt(1)
    v_mfma_f32_16x16x32_bf16 v[52:55], v[76:79], v[116:119], v[52:55]
    v_mfma_f32_16x16x32_bf16 v[56:59], v[76:79], v[120:123], v[56:59]
    s_waitcnt lgkmcnt(0)
    v_mfma_f32_16x16x32_bf16 v[60:63], v[80:83], v[116:119], v[60:63]
    v_mfma_f32_16x16x32_bf16 v[64:67], v[80:83], v[120:123], v[64:67]
    v_cvt_pk_bf16_f32 v92, v40, v41
    v_cvt_pk_bf16_f32 v93, v42, v43
    v_cvt_pk_bf16_f32 v8, v36, v37
    v_cvt_pk_bf16_f32 v9, v38, v39
    v_lshlrev_b32 v36, 16, v8
    v_and_b32 v37, 0xffff0000, v8
    v_lshlrev_b32 v38, 16, v9
    v_and_b32 v39, 0xffff0000, v9
    v_mul_f32 v12, v29, v36
    v_mul_f32 v13, v29, v37
    v_mul_f32 v14, v29, v38
    v_mul_f32 v15, v29, v39
    v_exp_f32 v12, v12 clamp
    v_exp_f32 v13, v13 clamp
    v_exp_f32 v14, v14 clamp
    v_exp_f32 v15, v15 clamp
    v_max_f32 v36, 0x358637bd, v36
    v_max_f32 v37, 0x358637bd, v37
    v_max_f32 v38, 0x358637bd, v38
    v_max_f32 v39, 0x358637bd, v39
    v_add_f32 v36, v36, v12
    v_add_f32 v37, v37, v13
    v_add_f32 v38, v38, v14
    v_add_f32 v39, v39, v15
    v_cvt_pk_bf16_f32 v84, v36, v37
    v_cvt_pk_bf16_f32 v85, v38, v39
    v_cvt_pk_bf16_f32 v94, v48, v49
    v_cvt_pk_bf16_f32 v95, v50, v51
    v_cvt_pk_bf16_f32 v8, v44, v45
    v_cvt_pk_bf16_f32 v9, v46, v47
    v_lshlrev_b32 v44, 16, v8
    v_and_b32 v45, 0xffff0000, v8
    v_lshlrev_b32 v46, 16, v9
    v_and_b32 v47, 0xffff0000, v9
    v_mul_f32 v12, v29, v44
    v_mul_f32 v13, v29, v45
    v_mul_f32 v14, v29, v46
    v_mul_f32 v15, v29, v47
    v_exp_f32 v12, v12 clamp
    v_exp_f32 v13, v13 clamp
    v_exp_f32 v14, v14 clamp
    v_exp_f32 v15, v15 clamp
    v_max_f32 v44, 0x358637bd, v44
    v_max_f32 v45, 0x358637bd, v45
    v_max_f32 v46, 0x358637bd, v46
    v_max_f32 v47, 0x358637bd, v47
    v_add_f32 v44, v44, v12
    v_add_f32 v45, v45, v13
    v_add_f32 v46, v46, v14
    v_add_f32 v47, v47, v15
    v_cvt_pk_bf16_f32 v86, v44, v45
    v_cvt_pk_bf16_f32 v87, v46, v47
    s_nop 1
    v_mfma_f32_16x16x32_bf16 v[124:127], v[92:95], v[84:87], 0
    v_mfma_f32_16x16x32_bf16 v[128:131], v[16:19], v[84:87], 0
    v_cvt_pk_bf16_f32 v96, v56, v57
    v_cvt_pk_bf16_f32 v97, v58, v59
    v_cvt_pk_bf16_f32 v8, v52, v53
    v_cvt_pk_bf16_f32 v9, v54, v55
    v_lshlrev_b32 v52, 16, v8
    v_and_b32 v53, 0xffff0000, v8
    v_lshlrev_b32 v54, 16, v9
    v_and_b32 v55, 0xffff0000, v9
    v_mul_f32 v12, v29, v52
    v_mul_f32 v13, v29, v53
    v_mul_f32 v14, v29, v54
    v_mul_f32 v15, v29, v55
    v_exp_f32 v12, v12 clamp
    v_exp_f32 v13, v13 clamp
    v_exp_f32 v14, v14 clamp
    v_exp_f32 v15, v15 clamp
    v_max_f32 v52, 0x358637bd, v52
    v_max_f32 v53, 0x358637bd, v53
    v_max_f32 v54, 0x358637bd, v54
    v_max_f32 v55, 0x358637bd, v55
    v_add_f32 v52, v52, v12
    v_add_f32 v53, v53, v13
    v_add_f32 v54, v54, v14
    v_add_f32 v55, v55, v15
    v_cvt_pk_bf16_f32 v88, v52, v53
    v_cvt_pk_bf16_f32 v89, v54, v55
    v_cvt_pk_bf16_f32 v98, v64, v65
    v_cvt_pk_bf16_f32 v99, v66, v67
    v_cvt_pk_bf16_f32 v8, v60, v61
    v_cvt_pk_bf16_f32 v9, v62, v63
    v_lshlrev_b32 v60, 16, v8
    v_and_b32 v61, 0xffff0000, v8
    v_lshlrev_b32 v62, 16, v9
    v_and_b32 v63, 0xffff0000, v9
    v_mul_f32 v12, v29, v60
    v_mul_f32 v13, v29, v61
    v_mul_f32 v14, v29, v62
    v_mul_f32 v15, v29, v63
    v_exp_f32 v12, v12 clamp
    v_exp_f32 v13, v13 clamp
    v_exp_f32 v14, v14 clamp
    v_exp_f32 v15, v15 clamp
    v_max_f32 v60, 0x358637bd, v60
    v_max_f32 v61, 0x358637bd, v61
    v_max_f32 v62, 0x358637bd, v62
    v_max_f32 v63, 0x358637bd, v63
    v_add_f32 v60, v60, v12
    v_add_f32 v61, v61, v13
    v_add_f32 v62, v62, v14
    v_add_f32 v63, v63, v15
    v_cvt_pk_bf16_f32 v90, v60, v61
    v_cvt_pk_bf16_f32 v91, v62, v63
    s_nop 1
    v_mfma_f32_16x16x32_bf16 v[124:127], v[96:99], v[88:91], v[124:127]
    v_mfma_f32_16x16x32_bf16 v[128:131], v[16:19], v[88:91], v[128:131]
    s_nop 6
    buffer_store_dwordx4 v[124:127], v3, s[44:47], s52 offen sc1
    s_mov_b64 exec, 0xffff
    buffer_store_dword v128, v30, s[44:47], s51 offen sc1
    s_endpgm
K1_FFT:
    s_sub_u32 s21, s20, 4
    s_setprio 2
    s_and_b32 s22, s16, 6
    s_and_b32 s23, s21, 1
    s_or_b32 s22, s22, s23
    s_and_b32 s23, s16, 1
    s_lshl_b32 s23, s23, 1
    s_lshr_b32 s21, s21, 1
    s_add_u32 s21, s21, s23
    v_mov_b32 v7, 0x0000bf80
    v_mov_b32 v8, 0xbf800000
    s_waitcnt lgkmcnt(0)
    s_mov_b32 s44, s14
    s_mov_b32 s45, s15
    s_mov_b32 s46, 0x1400000
    s_mov_b32 s47, 0x00020000
    v_lshrrev_b32 v3, 1, v2
    s_lshl_b32 s53, s21, 3
    v_add_u32 v3, s53, v3
    v_and_b32 v4, 1, v2
    v_mul_u32_u24 v36, s18, v3
    v_lshl_add_u32 v36, v4, 9, v36
    v_lshlrev_b32 v37, 5, v3
    v_and_b32 v39, 1, v3
    v_mul_u32_u24 v39, 0x8000, v39
    v_lshl_or_b32 v39, v39, 16, v39
    s_cmp_eq_u32 s21, 0
    s_cselect_b32 s54, 0x00020002, 0
    s_mov_b32 s55, s54
    s_mov_b64 exec, s[54:55]
    v_mov_b32 v37, 1024
    v_mov_b32 v36, 0
    s_mov_b64 exec, -1
    v_lshlrev_b32 v3, 3, v1
    v_mad_u32_u24 v36, v3, v37, v36
    v_cvt_f32_u32 v36, v36
    v_cvt_f32_u32 v37, v37
    v_mul_f32 v36, 0x3a000000, v36
    v_mul_f32 v37, 0x3a000000, v37
    v_add_f32 v3, v36, v37
    v_cos_f32 v38, v37
    v_cos_f32 v28, v36
    v_cos_f32 v29, v3
    v_add_f32 v38, v38, v38
    v_fma_f32 v30, v38, v29, -v28
    v_fma_f32 v31, v38, v30, -v29
    v_fma_f32 v32, v38, v31, -v30
    v_fma_f32 v33, v38, v32, -v31
    v_fma_f32 v34, v38, v33, -v32
    v_fma_f32 v35, v38, v34, -v33
    v_cvt_pk_bf16_f32 v12, v28, v29
    v_cvt_pk_bf16_f32 v13, v30, v31
    v_cvt_pk_bf16_f32 v14, v32, v33
    v_cvt_pk_bf16_f32 v15, v34, v35
    v_dot2c_f32_bf16 v28, v12, v7
    v_dot2c_f32_bf16 v29, v12, v8
    v_dot2c_f32_bf16 v30, v13, v7
    v_dot2c_f32_bf16 v31, v13, v8
    v_dot2c_f32_bf16 v32, v14, v7
    v_dot2c_f32_bf16 v33, v14, v8
    v_dot2c_f32_bf16 v34, v15, v7
    v_dot2c_f32_bf16 v35, v15, v8
    v_cvt_pk_bf16_f32 v16, v28, v29
    v_cvt_pk_bf16_f32 v17, v30, v31
    v_cvt_pk_bf16_f32 v18, v32, v33
    v_cvt_pk_bf16_f32 v19, v34, v35
    v_xor_b32 v20, v39, v12
    v_xor_b32 v21, v39, v13
    v_xor_b32 v22, v39, v14
    v_xor_b32 v23, v39, v15
    v_xor_b32 v24, v39, v16
    v_xor_b32 v25, v39, v17
    v_xor_b32 v26, v39, v18
    v_xor_b32 v27, v39, v19
    s_lshl_b32 s53, s22, 2
    v_lshl_add_u32 v3, v1, 5, s53
    v_mul_u32_u24 v36, v3, v2
    v_cvt_f32_u32 v36, v36
    v_mul_f32 v36, 0x3b000000, v36
    v_cvt_f32_u32 v37, v2
    v_mul_f32 v3, 0x3e800000, v37
    v_mul_f32 v37, 0x3b000000, v37
    v_cos_f32 v76, v36
    v_sin_f32 v80, v36
    v_cos_f32 v72, v37
    v_sin_f32 v73, v37
    v_cos_f32 v74, v3
    v_sin_f32 v75, v3
    v_rndne_f32 v74, v74
    v_rndne_f32 v75, v75
    v_and_b32 v39, 1, v2
    v_mul_u32_u24 v39, 0x8000, v39
    v_lshl_or_b32 v39, v39, 16, v39
    v_mul_f32 v3, v80, v73
    v_mul_f32 v4, v76, v73
    v_fma_f32 v77, v76, v72, -v3
    v_fma_f32 v81, v80, v72, v4
    v_mul_f32 v3, v81, v73
    v_mul_f32 v4, v77, v73
    v_fma_f32 v78, v77, v72, -v3
    v_fma_f32 v82, v81, v72, v4
    v_mul_f32 v3, v82, v73
    v_mul_f32 v4, v78, v73
    v_fma_f32 v79, v78, v72, -v3
    v_fma_f32 v83, v82, v72, v4
    v_mul_f32 v3, v80, v75
    v_mul_f32 v4, v76, v75
    v_fma_f32 v28, v76, v74, -v3
    v_fma_f32 v32, v80, v74, v4
    v_mul_f32 v3, v81, v75
    v_mul_f32 v4, v77, v75
    v_fma_f32 v29, v77, v74, -v3
    v_fma_f32 v33, v81, v74, v4
    v_mul_f32 v3, v82, v75
    v_mul_f32 v4, v78, v75
    v_fma_f32 v30, v78, v74, -v3
    v_fma_f32 v34, v82, v74, v4
    v_mul_f32 v3, v83, v75
    v_mul_f32 v4, v79, v75
    v_fma_f32 v31, v79, v74, -v3
    v_fma_f32 v35, v83, v74, v4
    v_cvt_pk_bf16_f32 v40, v76, v28
    v_cvt_pk_bf16_f32 v48, v77, v29
    v_cvt_pk_bf16_f32 v56, v78, v30
    v_cvt_pk_bf16_f32 v64, v79, v31
    v_cvt_pk_bf16_f32 v44, v80, v32
    v_cvt_pk_bf16_f32 v52, v81, v33
    v_cvt_pk_bf16_f32 v60, v82, v34
    v_cvt_pk_bf16_f32 v68, v83, v35
    v_dot2c_f32_bf16 v76, v40, v7
    v_dot2c_f32_bf16 v28, v40, v8
    v_dot2c_f32_bf16 v77, v48, v7
    v_dot2c_f32_bf16 v29, v48, v8
    v_dot2c_f32_bf16 v78, v56, v7
    v_dot2c_f32_bf16 v30, v56, v8
    v_dot2c_f32_bf16 v79, v64, v7
    v_dot2c_f32_bf16 v31, v64, v8
    v_dot2c_f32_bf16 v80, v44, v7
    v_dot2c_f32_bf16 v32, v44, v8
    v_dot2c_f32_bf16 v81, v52, v7
    v_dot2c_f32_bf16 v33, v52, v8
    v_dot2c_f32_bf16 v82, v60, v7
    v_dot2c_f32_bf16 v34, v60, v8
    v_dot2c_f32_bf16 v83, v68, v7
    v_dot2c_f32_bf16 v35, v68, v8
    v_cvt_pk_bf16_f32 v42, v76, v28
    v_cvt_pk_bf16_f32 v50, v77, v29
    v_cvt_pk_bf16_f32 v58, v78, v30
    v_cvt_pk_bf16_f32 v66, v79, v31
    v_cvt_pk_bf16_f32 v46, v80, v32
    v_cvt_pk_bf16_f32 v54, v81, v33
    v_cvt_pk_bf16_f32 v62, v82, v34
    v_cvt_pk_bf16_f32 v70, v83, v35
    v_xor_b32 v41, v39, v40
    v_xor_b32 v43, v39, v42
    v_xor_b32 v45, v39, v44
    v_xor_b32 v47, v39, v46
    v_xor_b32 v49, v39, v48
    v_xor_b32 v51, v39, v50
    v_xor_b32 v53, v39, v52
    v_xor_b32 v55, v39, v54
    v_xor_b32 v57, v39, v56
    v_xor_b32 v59, v39, v58
    v_xor_b32 v61, v39, v60
    v_xor_b32 v63, v39, v62
    v_xor_b32 v65, v39, v64
    v_xor_b32 v67, v39, v66
    v_xor_b32 v69, v39, v68
    v_xor_b32 v71, v39, v70
    v_bfe_u32 v3, v0, 2, 2
    v_lshl_add_u32 v3, v1, 3, v3
    v_and_b32 v4, 3, v0
    s_lshr_b32 s53, s22, 1
    v_lshl_add_u32 v4, v4, 2, s53
    v_and_b32 v5, 15, v3
    v_xor_b32 v4, v4, v5
    v_lshlrev_b32 v4, 4, v4
    v_lshl_add_u32 v4, v3, 8, v4
    s_and_b32 s53, s22, 1
    s_lshl_b32 s53, s53, 3
    s_add_u32 s53, s53, 98304
    v_add_u32 v84, s53, v4
    v_xor_b32 v85, 64, v84
    v_cvt_f32_u32 v72, s18
    v_mul_f32 v72, 0x3c800000, v72
    v_sin_f32 v73, v72
    v_cos_f32 v72, v72
    v_and_b32 v3, 3, v0
    v_lshlrev_b32 v75, 7, v3
    v_bfe_u32 v3, v0, 2, 2
    v_lshl_add_u32 v75, v3, 4, v75
    v_lshl_add_u32 v74, v1, 17, v75
    s_lshl_b32 s62, s21, 19
    s_lshl_b32 s53, s18, 11
    s_lshr_b32 s66, s22, 1
    s_lshl_b32 s66, s66, 9
    s_add_u32 s66, s66, s53
    s_and_b32 s53, s22, 1
    s_lshl_b32 s53, s53, 6
    s_add_u32 s66, s66, s53
    s_add_u32 s62, s62, s66
    s_add_u32 s63, s62, 65536
    s_add_u32 s66, s66, 2097152
    s_cmp_eq_u32 s21, 0
    s_cselect_b64 s[54:55], 0xffff, 0
    s_barrier
    s_barrier
    s_barrier
    ds_read_b64_tr_b16 v[88:89], v84 offset:0
    ds_read_b64_tr_b16 v[90:91], v85 offset:1024
    ds_read_b64_tr_b16 v[92:93], v84 offset:8192
    ds_read_b64_tr_b16 v[94:95], v85 offset:9216
    ds_read_b64_tr_b16 v[96:97], v84 offset:16384
    ds_read_b64_tr_b16 v[98:99], v85 offset:17408
    ds_read_b64_tr_b16 v[100:101], v84 offset:24576
    ds_read_b64_tr_b16 v[102:103], v85 offset:25600
    ds_read_b64_tr_b16 v[104:105], v84 offset:32768
    ds_read_b64_tr_b16 v[106:107], v85 offset:33792
    ds_read_b64_tr_b16 v[108:109], v84 offset:40960
    ds_read_b64_tr_b16 v[110:111], v85 offset:41984
    ds_read_b64_tr_b16 v[112:113], v84 offset:49152
    ds_read_b64_tr_b16 v[114:115], v85 offset:50176
    ds_read_b64_tr_b16 v[116:117], v84 offset:57344
    s_waitcnt lgkmcnt(14)
    ds_read_b64_tr_b16 v[118:119], v85 offset:58368
    s_waitcnt lgkmcnt(14)
    v_mfma_f32_16x16x32_bf16 v[120:123], v[88:91], v[12:15], 0
    v_mfma_f32_16x16x32_bf16 v[120:123], v[88:91], v[16:19], v[120:123]
    s_waitcnt lgkmcnt(12)
    v_mfma_f32_16x16x32_bf16 v[120:123], v[92:95], v[20:23], v[120:123]
    v_mfma_f32_16x16x32_bf16 v[120:123], v[92:95], v[24:27], v[120:123]
    s_waitcnt lgkmcnt(10)
    v_mfma_f32_16x16x32_bf16 v[124:127], v[96:99], v[12:15], 0
    v_mfma_f32_16x16x32_bf16 v[124:127], v[96:99], v[16:19], v[124:127]
    s_waitcnt lgkmcnt(8)
    v_mfma_f32_16x16x32_bf16 v[124:127], v[100:103], v[20:23], v[124:127]
    v_mfma_f32_16x16x32_bf16 v[124:127], v[100:103], v[24:27], v[124:127]
    s_waitcnt lgkmcnt(6)
    v_mfma_f32_16x16x32_bf16 v[128:131], v[104:107], v[12:15], 0
    v_mfma_f32_16x16x32_bf16 v[128:131], v[104:107], v[16:19], v[128:131]
    s_waitcnt lgkmcnt(4)
    v_mfma_f32_16x16x32_bf16 v[128:131], v[108:111], v[20:23], v[128:131]
    v_mfma_f32_16x16x32_bf16 v[128:131], v[108:111], v[24:27], v[128:131]
    s_waitcnt lgkmcnt(2)
    v_mfma_f32_16x16x32_bf16 v[132:135], v[112:115], v[12:15], 0
    v_mfma_f32_16x16x32_bf16 v[132:135], v[112:115], v[16:19], v[132:135]
    s_waitcnt lgkmcnt(0)
    v_mfma_f32_16x16x32_bf16 v[132:135], v[116:119], v[20:23], v[132:135]
    v_mfma_f32_16x16x32_bf16 v[132:135], v[116:119], v[24:27], v[132:135]
    s_barrier
    v_cvt_pk_bf16_f32 v136, v120, v124
    v_mov_b32 v138, v136
    s_nop 4
    v_cvt_pk_bf16_f32 v137, v128, v132
    v_mov_b32 v139, v137
    v_cvt_pk_bf16_f32 v140, v121, v125
    v_mov_b32 v142, v140
    v_cvt_pk_bf16_f32 v141, v129, v133
    v_mov_b32 v143, v141
    v_dot2c_f32_bf16 v120, v136, v7
    v_dot2c_f32_bf16 v124, v136, v8
    v_dot2c_f32_bf16 v128, v137, v7
    v_dot2c_f32_bf16 v132, v137, v8
    v_dot2c_f32_bf16 v121, v140, v7
    v_dot2c_f32_bf16 v125, v140, v8
    v_dot2c_f32_bf16 v129, v141, v7
    v_dot2c_f32_bf16 v133, v141, v8
    v_cvt_pk_bf16_f32 v152, v120, v124
    v_mov_b32 v154, v152
    v_cvt_pk_bf16_f32 v153, v128, v132
    v_mov_b32 v155, v153
    v_cvt_pk_bf16_f32 v156, v121, v125
    v_mov_b32 v158, v156
    v_cvt_pk_bf16_f32 v157, v129, v133
    v_mov_b32 v159, v157
    v_mfma_f32_16x16x32_bf16 v[88:91], v[136:139], v[40:43], 0
    v_mfma_f32_16x16x32_bf16 v[88:91], v[152:155], v[40:43], v[88:91]
    v_mfma_f32_16x16x32_bf16 v[92:95], v[136:139], v[44:47], 0
    v_mfma_f32_16x16x32_bf16 v[92:95], v[152:155], v[44:47], v[92:95]
    v_mfma_f32_16x16x32_bf16 v[96:99], v[140:143], v[48:51], 0
    v_mfma_f32_16x16x32_bf16 v[96:99], v[156:159], v[48:51], v[96:99]
    v_mfma_f32_16x16x32_bf16 v[100:103], v[140:143], v[52:55], 0
    v_mfma_f32_16x16x32_bf16 v[100:103], v[156:159], v[52:55], v[100:103]
    s_barrier
    v_cvt_pk_bf16_f32 v144, v122, v126
    v_mov_b32 v146, v144
    v_cvt_pk_bf16_f32 v145, v130, v134
    v_mov_b32 v147, v145
    v_cvt_pk_bf16_f32 v148, v123, v127
    v_mov_b32 v150, v148
    v_cvt_pk_bf16_f32 v149, v131, v135
    v_mov_b32 v151, v149
    v_dot2c_f32_bf16 v122, v144, v7
    v_dot2c_f32_bf16 v126, v144, v8
    v_dot2c_f32_bf16 v130, v145, v7
    v_dot2c_f32_bf16 v134, v145, v8
    v_dot2c_f32_bf16 v123, v148, v7
    v_dot2c_f32_bf16 v127, v148, v8
    v_dot2c_f32_bf16 v131, v149, v7
    v_dot2c_f32_bf16 v135, v149, v8
    v_cvt_pk_bf16_f32 v160, v122, v126
    v_mov_b32 v162, v160
    v_cvt_pk_bf16_f32 v161, v130, v134
    v_mov_b32 v163, v161
    v_cvt_pk_bf16_f32 v164, v123, v127
    v_mov_b32 v166, v164
    v_cvt_pk_bf16_f32 v165, v131, v135
    v_mov_b32 v167, v165
    v_mfma_f32_16x16x32_bf16 v[104:107], v[144:147], v[56:59], 0
    v_mfma_f32_16x16x32_bf16 v[104:107], v[160:163], v[56:59], v[104:107]
    v_mfma_f32_16x16x32_bf16 v[108:111], v[144:147], v[60:63], 0
    v_mfma_f32_16x16x32_bf16 v[108:111], v[160:163], v[60:63], v[108:111]
    v_mfma_f32_16x16x32_bf16 v[112:115], v[148:151], v[64:67], 0
    v_mfma_f32_16x16x32_bf16 v[112:115], v[164:167], v[64:67], v[112:115]
    v_mfma_f32_16x16x32_bf16 v[116:119], v[148:151], v[68:71], 0
    v_mfma_f32_16x16x32_bf16 v[116:119], v[164:167], v[68:71], v[116:119]
    s_barrier
    v_add_f32 v12, v88, v93
    v_sub_f32 v24, v89, v92
    v_add_f32 v16, v90, v95
    v_sub_f32 v120, v91, v94
    v_add_f32 v13, v96, v101
    v_sub_f32 v25, v97, v100
    v_add_f32 v17, v98, v103
    v_sub_f32 v121, v99, v102
    v_add_f32 v14, v104, v109
    v_sub_f32 v26, v105, v108
    v_add_f32 v18, v106, v111
    v_sub_f32 v122, v107, v110
    v_add_f32 v15, v112, v117
    v_sub_f32 v27, v113, v116
    v_add_f32 v19, v114, v119
    v_sub_f32 v123, v115, v118
    s_mov_b64 exec, s[54:55]
    v_mov_b32 v12, v88
    v_xor_b32 v24, 0x80000000, v92
    v_mov_b32 v13, v96
    v_xor_b32 v25, 0x80000000, v100
    v_mov_b32 v14, v104
    v_xor_b32 v26, 0x80000000, v108
    v_mov_b32 v15, v112
    v_xor_b32 v27, 0x80000000, v116
    s_mov_b64 exec, -1
    v_cvt_pk_bf16_f32 v136, v12, v13
    v_cvt_pk_bf16_f32 v138, v24, v25
    v_cvt_pk_bf16_f32 v137, v14, v15
    v_cvt_pk_bf16_f32 v139, v26, v27
    v_cvt_pk_bf16_f32 v144, v16, v17
    v_cvt_pk_bf16_f32 v146, v120, v121
    v_cvt_pk_bf16_f32 v145, v18, v19
    v_cvt_pk_bf16_f32 v147, v122, v123
    buffer_store_dwordx4 v[136:139], v74, s[44:47], s62 offen sc1
    buffer_store_dwordx4 v[144:147], v74, s[44:47], s63 offen sc1
    s_cmp_lg_u32 s21, 0
    s_cbranch_scc1 K1_NOSP
    v_mul_f32 v5, v93, v73
    v_fma_f32 v20, v89, v72, -v5
    v_mul_f32 v6, v93, v72
    v_fma_f32 v124, -v89, v73, -v6
    v_mul_f32 v5, v101, v73
    v_fma_f32 v21, v97, v72, -v5
    v_mul_f32 v6, v101, v72
    v_fma_f32 v125, -v97, v73, -v6
    v_mul_f32 v5, v109, v73
    v_fma_f32 v22, v105, v72, -v5
    v_mul_f32 v6, v109, v72
    v_fma_f32 v126, -v105, v73, -v6
    v_mul_f32 v5, v117, v73
    v_fma_f32 v23, v113, v72, -v5
    v_mul_f32 v6, v117, v72
    v_fma_f32 v127, -v113, v73, -v6
    v_cvt_pk_bf16_f32 v152, v20, v21
    v_cvt_pk_bf16_f32 v154, v124, v125
    v_cvt_pk_bf16_f32 v153, v22, v23
    v_cvt_pk_bf16_f32 v155, v126, v127
    s_mov_b64 exec, 0xffff
    buffer_store_dwordx4 v[152:155], v75, s[44:47], s66 offen sc1
    s_mov_b64 exec, -1
K1_NOSP:
K1_END:
    s_endpgm
.globl gm_k2_kernel
.p2align 8
.type gm_k2_kernel,@function
gm_k2_kernel:
    s_cmp_ge_u32 s2, 256
    s_cbranch_scc1 K2_END
    s_load_dwordx4 s[4:7], s[0:1], 0
    s_load_dwordx2 s[8:9], s[0:1], 16
    s_load_dwordx2 s[14:15], s[0:1], 72
    v_lshrrev_b32 v1, 6, v0
    v_and_b32 v0, 63, v0
    v_readfirstlane_b32 s19, v1
    v_mov_b32 v2, 0
    v_mov_b32 v4, 0
    v_mov_b32 v5, 0
    v_mov_b32 v6, 0
    v_mov_b32 v7, 0
    ds_write_b128 v2, v[4:7]
    ds_write_b128 v2, v[4:7] offset:16
    s_waitcnt lgkmcnt(0)
    s_mov_b32 s44, s14
    s_mov_b32 s45, s15
    s_mov_b32 s46, 0x1400000
    s_mov_b32 s47, 0x00020000
    s_and_b32 s20, s19, 3
    s_mov_b32 s32, s8
    s_mov_b32 s33, s9
    s_mov_b32 s34, 0x80000
    s_mov_b32 s35, 0x00020000
    s_barrier
    s_cmp_ge_u32 s2, 128
    s_cbranch_scc1 K2_Q
    s_cmp_ge_u32 s19, 4
    s_cbranch_scc1 K2_UP
K2_FFT:
    s_setprio 3
    s_lshr_b32 s16, s2, 5
    s_lshl_b32 s16, s16, 3
    s_and_b32 s48, s2, 7
    s_add_u32 s16, s16, s48
    s_bfe_u32 s17, s2, 0x20003
    s_lshr_b32 s62, s19, 2
    s_mul_i32 s61, s62, 69632
    s_cmp_eq_u32 s62, 1
    s_cselect_b32 s16, 32, s16
    s_lshl_b32 s62, s62, 4
    s_add_u32 s63, s62, 4
    s_add_u32 s64, s62, 8
    v_and_b32 v5, 31, v0
    v_lshrrev_b32 v6, 5, v0
    s_and_b32 s48, s20, 1
    s_lshl_b32 s48, s48, 3
    v_xor_b32 v1, s48, v5
    v_xor_b32 v1, v1, v6
    v_lshrrev_b32 v2, 3, v1
    v_and_b32 v1, 7, v1
    v_lshlrev_b32 v1, 4, v1
    v_lshl_add_u32 v1, v2, 9, v1
    v_lshl_add_u32 v7, v6, 11, v1
    v_xor_b32 v8, 32, v7
    v_add_u32 v8, 3072, v8
    v_xor_b32 v9, 64, v7
    v_add_u32 v9, 6144, v9
    v_xor_b32 v10, 96, v7
    v_add_u32 v10, 9216, v10
    s_lshl_b32 s48, s16, 16
    s_lshl_b32 s49, s20, 14
    s_add_u32 s48, s48, s49
    s_lshl_b32 s50, s17, 9
    s_add_u32 s51, s48, s50
    s_add_u32 s51, s51, 5242880
    s_lshl_b32 s49, s17, 7
    s_add_u32 s48, s48, s49
    s_lshl_b32 s49, s20, 12
    s_add_u32 s49, s49, s61
    s_add_u32 m0, s49, 1024
    s_nop 0
    buffer_load_dwordx4 v7, s[44:47], s48 offen offset:0 lds
    buffer_load_dwordx4 v8, s[44:47], s48 offen offset:1024 lds
    buffer_load_dwordx4 v9, s[44:47], s48 offen offset:2048 lds
    buffer_load_dwordx4 v10, s[44:47], s48 offen offset:3072 lds
    v_lshlrev_b32 v1, 4, v5
    v_lshl_add_u32 v1, v6, 11, v1
    s_mul_i32 s49, s20, 4160
    s_add_u32 s49, s49, s61
    s_add_u32 m0, s49, 17408
    s_nop 0
    buffer_load_dwordx4 v1, s[44:47], s51 offen lds
    s_add_u32 m0, m0, 1040
    s_add_u32 s51, s51, 4096
    buffer_load_dwordx4 v1, s[44:47], s51 offen lds
    s_add_u32 m0, m0, 1040
    s_add_u32 s51, s51, 4096
    buffer_load_dwordx4 v1, s[44:47], s51 offen lds
    s_add_u32 m0, m0, 1040
    s_add_u32 s51, s51, 4096
    buffer_load_dwordx4 v1, s[44:47], s51 offen lds
    s_lshl_b32 s18, s20, 2
    s_add_u32 s18, s18, s17
    v_cvt_f32_u32 v1, v5
    v_mul_f32 v128, 0x3d000000, v1
    v_mul_f32 v2, 0x3e800000, v1
    v_cos_f32 v130, v128
    v_sin_f32 v131, v128
    v_cos_f32 v132, v2
    v_sin_f32 v133, v2
    v_lshlrev_b32 v3, 2, v6
    v_cvt_f32_u32 v3, v3
    v_mul_f32 v129, v3, v128
    v_rndne_f32 v132, v132
    v_rndne_f32 v133, v133
    v_and_b32 v134, 1, v5
    v_mul_u32_u24 v134, 0x8000, v134
    v_lshl_or_b32 v134, v134, 16, v134
    v_mov_b32 v135, 0x80008000
    v_cos_f32 v96, v129
    v_sin_f32 v112, v129
    s_nop 0
    v_mul_f32 v1, v112, v131
    v_mul_f32 v2, v96, v131
    v_fma_f32 v97, v96, v130, -v1
    v_fma_f32 v113, v112, v130, v2
    v_mul_f32 v1, v113, v131
    v_mul_f32 v2, v97, v131
    v_fma_f32 v98, v97, v130, -v1
    v_fma_f32 v114, v113, v130, v2
    v_mul_f32 v1, v114, v131
    v_mul_f32 v2, v98, v131
    v_fma_f32 v99, v98, v130, -v1
    v_fma_f32 v115, v114, v130, v2
    v_mul_f32 v1, v112, v133
    v_mul_f32 v2, v96, v133
    v_fma_f32 v100, v96, v132, -v1
    v_fma_f32 v116, v112, v132, v2
    v_mul_f32 v1, v113, v133
    v_mul_f32 v2, v97, v133
    v_fma_f32 v101, v97, v132, -v1
    v_fma_f32 v117, v113, v132, v2
    v_mul_f32 v1, v114, v133
    v_mul_f32 v2, v98, v133
    v_fma_f32 v102, v98, v132, -v1
    v_fma_f32 v118, v114, v132, v2
    v_mul_f32 v1, v115, v133
    v_mul_f32 v2, v99, v133
    v_fma_f32 v103, v99, v132, -v1
    v_fma_f32 v119, v115, v132, v2
    v_cvt_pk_bf16_f32 v16, v96, v97
    v_cvt_pk_bf16_f32 v24, v112, v113
    v_cvt_pk_bf16_f32 v17, v98, v99
    v_cvt_pk_bf16_f32 v25, v114, v115
    v_cvt_pk_bf16_f32 v18, v100, v101
    v_cvt_pk_bf16_f32 v26, v116, v117
    v_cvt_pk_bf16_f32 v19, v102, v103
    v_cvt_pk_bf16_f32 v27, v118, v119
    v_xor_b32 v20, v134, v16
    v_xor_b32 v28, v134, v24
    v_xor_b32 v21, v134, v17
    v_xor_b32 v29, v134, v25
    v_xor_b32 v22, v134, v18
    v_xor_b32 v30, v134, v26
    v_xor_b32 v23, v134, v19
    v_xor_b32 v31, v134, v27
    v_xor_b32 v32, v135, v24
    v_xor_b32 v33, v135, v25
    v_xor_b32 v34, v135, v26
    v_xor_b32 v35, v135, v27
    v_xor_b32 v36, v135, v28
    v_xor_b32 v37, v135, v29
    v_xor_b32 v38, v135, v30
    v_xor_b32 v39, v135, v31
    v_cvt_f32_u32 v2, s18
    v_mul_f32 v2, 0x3d800000, v2
    v_fmac_f32 v129, v2, v128
    v_cos_f32 v96, v129
    v_sin_f32 v112, v129
    s_nop 0
    v_mul_f32 v1, v112, v131
    v_mul_f32 v2, v96, v131
    v_fma_f32 v97, v96, v130, -v1
    v_fma_f32 v113, v112, v130, v2
    v_mul_f32 v1, v113, v131
    v_mul_f32 v2, v97, v131
    v_fma_f32 v98, v97, v130, -v1
    v_fma_f32 v114, v113, v130, v2
    v_mul_f32 v1, v114, v131
    v_mul_f32 v2, v98, v131
    v_fma_f32 v99, v98, v130, -v1
    v_fma_f32 v115, v114, v130, v2
    v_mul_f32 v1, v112, v133
    v_mul_f32 v2, v96, v133
    v_fma_f32 v100, v96, v132, -v1
    v_fma_f32 v116, v112, v132, v2
    v_mul_f32 v1, v113, v133
    v_mul_f32 v2, v97, v133
    v_fma_f32 v101, v97, v132, -v1
    v_fma_f32 v117, v113, v132, v2
    v_mul_f32 v1, v114, v133
    v_mul_f32 v2, v98, v133
    v_fma_f32 v102, v98, v132, -v1
    v_fma_f32 v118, v114, v132, v2
    v_mul_f32 v1, v115, v133
    v_mul_f32 v2, v99, v133
    v_fma_f32 v103, v99, v132, -v1
    v_fma_f32 v119, v115, v132, v2
    v_cvt_pk_bf16_f32 v40, v96, v97
    v_cvt_pk_bf16_f32 v48, v112, v113
    v_cvt_pk_bf16_f32 v41, v98, v99
    v_cvt_pk_bf16_f32 v49, v114, v115
    v_cvt_pk_bf16_f32 v42, v100, v101
    v_cvt_pk_bf16_f32 v50, v116, v117
    v_cvt_pk_bf16_f32 v43, v102, v103
    v_cvt_pk_bf16_f32 v51, v118, v119
    v_xor_b32 v44, v134, v40
    v_xor_b32 v52, v134, v48
    v_xor_b32 v45, v134, v41
    v_xor_b32 v53, v134, v49
    v_xor_b32 v46, v134, v42
    v_xor_b32 v54, v134, v50
    v_xor_b32 v47, v134, v43
    v_xor_b32 v55, v134, v51
    v_xor_b32 v56, v135, v48
    v_xor_b32 v57, v135, v49
    v_xor_b32 v58, v135, v50
    v_xor_b32 v59, v135, v51
    v_xor_b32 v60, v135, v52
    v_xor_b32 v61, v135, v53
    v_xor_b32 v62, v135, v54
    v_xor_b32 v63, v135, v55
    v_lshlrev_b32 v1, 2, v6
    v_add_u32 v1, s20, v1
    v_and_b32 v2, 15, v5
    v_xor_b32 v1, v1, v2
    v_lshlrev_b32 v1, 4, v1
    v_lshl_add_u32 v1, v5, 9, v1
    v_add_u32 v1, s61, v1
    v_add_u32 v7, 1024, v1
    v_xor_b32 v8, 128, v7
    v_lshrrev_b32 v1, 1, v5
    v_mul_u32_u24 v1, 1040, v1
    v_and_b32 v2, 1, v5
    v_lshl_add_u32 v1, v2, 9, v1
    v_lshl_add_u32 v1, v6, 6, v1
    s_lshl_b32 s48, s20, 2
    s_add_u32 s48, s48, 17408
    s_add_u32 s48, s48, s61
    v_add_u32 v9, s48, v1
    s_lshl_b32 s48, s20, 13
    s_add_u32 s48, s48, 36864
    s_add_u32 s48, s48, s61
    v_lshl_add_u32 v2, v6, 1, v5
    v_lshlrev_b32 v3, 9, v6
    v_add_u32 v3, s48, v3
    v_add_u32 v1, 0, v2
    v_and_b32 v1, 31, v1
    v_lshl_add_u32 v130, v1, 4, v3
    v_add_u32 v1, 4, v2
    v_and_b32 v1, 31, v1
    v_lshl_add_u32 v131, v1, 4, v3
    v_add_u32 v1, 8, v2
    v_and_b32 v1, 31, v1
    v_lshl_add_u32 v128, v1, 4, v3
    v_add_u32 v1, 12, v2
    v_and_b32 v1, 31, v1
    v_lshl_add_u32 v129, v1, 4, v3
    s_lshl_b32 s48, s20, 3
    v_lshrrev_b32 v132, 3, v0
    v_add_u32 v132, s48, v132
    v_and_b32 v2, 7, v0
    v_lshl_add_u32 v1, v2, 1, v132
    v_and_b32 v1, 31, v1
    v_lshlrev_b32 v1, 4, v1
    v_and_b32 v3, 1, v0
    v_lshl_add_u32 v1, v3, 9, v1
    v_bfe_u32 v3, v0, 1, 2
    v_lshl_add_u32 v1, v3, 11, v1
    v_add_u32 v1, s61, v1
    v_add_u32 v133, 36864, v1
    s_cmp_eq_u32 s16, 32
    s_cselect_b32 s50, 0x3c800000, 0
    v_cvt_f32_u32 v1, v132
    v_mul_f32 v1, s50, v1
    v_cvt_f32_u32 v3, s17
    v_mul_f32 v3, 0x3d800000, v3
    v_cos_f32 v184, v1
    v_sin_f32 v185, v1
    v_add_f32 v1, v1, v3
    v_cos_f32 v186, v1
    v_sin_f32 v187, v1
    v_add_f32 v1, v1, v3
    v_cos_f32 v188, v1
    v_sin_f32 v189, v1
    v_add_f32 v1, v1, v3
    v_cos_f32 v190, v1
    v_sin_f32 v191, v1
    s_mov_b32 s48, 67584
    v_mul_lo_u32 v132, v132, s48
    v_lshl_add_u32 v132, v2, 4, v132
    s_lshl_b32 s52, s16, 9
    s_lshl_b32 s49, s17, 7
    s_add_u32 s52, s52, s49
    s_add_u32 s52, s52, 13631488
    s_waitcnt vmcnt(4)
    v_mov_b32 v1, s62
    v_mov_b32 v2, 1
    s_mov_b64 exec, 1
    ds_add_u32 v1, v2
SWB_F0:
    ds_read_b32 v2, v1
    s_waitcnt lgkmcnt(0)
    v_readfirstlane_b32 s48, v2
    s_nop 0
    s_cmp_lt_u32 s48, 4
    s_cbranch_scc1 SWB_F0
    s_mov_b64 exec, -1
    ds_read_b64 v[136:137], v7 offset:0
    ds_read_b64 v[138:139], v8 offset:0
    ds_read_b64 v[140:141], v7 offset:256
    ds_read_b64 v[142:143], v8 offset:256
    ds_read_b64 v[144:145], v7 offset:8
    ds_read_b64 v[146:147], v8 offset:8
    ds_read_b64 v[148:149], v7 offset:264
    ds_read_b64 v[150:151], v8 offset:264
    s_waitcnt lgkmcnt(6)
    v_mfma_f32_32x32x16_bf16 v[64:79], v[136:139], v[16:19], 0
    s_waitcnt lgkmcnt(4)
    v_mfma_f32_32x32x16_bf16 v[64:79], v[140:143], v[20:23], v[64:79]
    v_mfma_f32_32x32x16_bf16 v[80:95], v[136:139], v[32:35], 0
    v_mfma_f32_32x32x16_bf16 v[80:95], v[140:143], v[36:39], v[80:95]
    s_waitcnt vmcnt(0)
    s_waitcnt lgkmcnt(0)
    v_mov_b32 v1, s63
    v_mov_b32 v2, 1
    s_mov_b64 exec, 1
    ds_add_u32 v1, v2
SWB_F1:
    ds_read_b32 v2, v1
    s_waitcnt lgkmcnt(0)
    v_readfirstlane_b32 s48, v2
    s_nop 0
    s_cmp_lt_u32 s48, 4
    s_cbranch_scc1 SWB_F1
    s_mov_b64 exec, -1
    v_mfma_f32_32x32x16_bf16 v[64:79], v[144:147], v[24:27], v[64:79]
    ds_read2_b32 v[152:153], v9 offset0:0 offset1:4
    ds_read2_b32 v[154:155], v9 offset0:8 offset1:12
    ds_read2_b32 v[156:157], v9 offset0:32 offset1:36
    ds_read2_b32 v[158:159], v9 offset0:40 offset1:44
    ds_read2_b32 v[160:161], v9 offset0:64 offset1:68
    ds_read2_b32 v[162:163], v9 offset0:72 offset1:76
    v_mfma_f32_32x32x16_bf16 v[64:79], v[148:151], v[28:31], v[64:79]
    ds_read2_b32 v[164:165], v9 offset0:96 offset1:100
    ds_read2_b32 v[166:167], v9 offset0:104 offset1:108
    v_mfma_f32_32x32x16_bf16 v[80:95], v[144:147], v[16:19], v[80:95]
    v_mfma_f32_32x32x16_bf16 v[80:95], v[148:151], v[20:23], v[80:95]
    s_nop 7
    v_cvt_pk_bf16_f32 v136, v64, v65
    v_cvt_pk_bf16_f32 v137, v66, v67
    v_cvt_pk_bf16_f32 v138, v68, v69
    v_cvt_pk_bf16_f32 v139, v70, v71
    v_cvt_pk_bf16_f32 v140, v72, v73
    v_cvt_pk_bf16_f32 v141, v74, v75
    v_cvt_pk_bf16_f32 v142, v76, v77
    v_cvt_pk_bf16_f32 v143, v78, v79
    v_mfma_f32_32x32x16_bf16 v[96:111], v[136:139], v[16:19], 0
    v_cvt_pk_bf16_f32 v144, v80, v81
    v_cvt_pk_bf16_f32 v145, v82, v83
    v_cvt_pk_bf16_f32 v146, v84, v85
    v_cvt_pk_bf16_f32 v147, v86, v87
    v_cvt_pk_bf16_f32 v148, v88, v89
    v_cvt_pk_bf16_f32 v149, v90, v91
    v_mfma_f32_32x32x16_bf16 v[96:111], v[140:143], v[20:23], v[96:111]
    v_cvt_pk_bf16_f32 v150, v92, v93
    v_cvt_pk_bf16_f32 v151, v94, v95
    v_mfma_f32_32x32x16_bf16 v[112:127], v[136:139], v[32:35], 0
    v_mfma_f32_32x32x16_bf16 v[112:127], v[140:143], v[36:39], v[112:127]
    v_mfma_f32_32x32x16_bf16 v[96:111], v[144:147], v[24:27], v[96:111]
    s_waitcnt lgkmcnt(7)
    v_lshlrev_b32 v168, 16, v152
    v_and_b32 v152, 0xffff0000, v152
    v_lshlrev_b32 v169, 16, v153
    v_and_b32 v153, 0xffff0000, v153
    s_waitcnt lgkmcnt(6)
    v_lshlrev_b32 v170, 16, v154
    v_and_b32 v154, 0xffff0000, v154
    v_mfma_f32_32x32x16_bf16 v[96:111], v[148:151], v[28:31], v[96:111]
    v_lshlrev_b32 v171, 16, v155
    v_and_b32 v155, 0xffff0000, v155
    s_waitcnt lgkmcnt(5)
    v_lshlrev_b32 v172, 16, v156
    v_and_b32 v156, 0xffff0000, v156
    v_lshlrev_b32 v173, 16, v157
    v_and_b32 v157, 0xffff0000, v157
    v_mfma_f32_32x32x16_bf16 v[112:127], v[144:147], v[16:19], v[112:127]
    s_waitcnt lgkmcnt(4)
    v_lshlrev_b32 v174, 16, v158
    v_and_b32 v158, 0xffff0000, v158
    v_lshlrev_b32 v175, 16, v159
    v_and_b32 v159, 0xffff0000, v159
    s_waitcnt lgkmcnt(3)
    v_lshlrev_b32 v176, 16, v160
    v_and_b32 v160, 0xffff0000, v160
    v_mfma_f32_32x32x16_bf16 v[112:127], v[148:151], v[20:23], v[112:127]
    v_lshlrev_b32 v177, 16, v161
    v_and_b32 v161, 0xffff0000, v161
    s_waitcnt lgkmcnt(2)
    v_lshlrev_b32 v178, 16, v162
    v_and_b32 v162, 0xffff0000, v162
    v_lshlrev_b32 v179, 16, v163
    v_and_b32 v163, 0xffff0000, v163
    s_waitcnt lgkmcnt(1)
    v_lshlrev_b32 v180, 16, v164
    v_and_b32 v164, 0xffff0000, v164
    v_lshlrev_b32 v181, 16, v165
    v_and_b32 v165, 0xffff0000, v165
    s_waitcnt lgkmcnt(0)
    v_lshlrev_b32 v182, 16, v166
    v_and_b32 v166, 0xffff0000, v166
    v_lshlrev_b32 v183, 16, v167
    v_and_b32 v167, 0xffff0000, v167
    v_mul_f32 v64, v96, v168
    v_mul_f32 v65, v97, v169
    v_mul_f32 v66, v98, v170
    v_mul_f32 v67, v99, v171
    v_mul_f32 v68, v100, v172
    v_mul_f32 v69, v101, v173
    v_mul_f32 v70, v102, v174
    v_mul_f32 v71, v103, v175
    v_mul_f32 v72, v104, v176
    v_mul_f32 v73, v105, v177
    v_mul_f32 v74, v106, v178
    v_mul_f32 v75, v107, v179
    v_mul_f32 v76, v108, v180
    v_mul_f32 v77, v109, v181
    v_mul_f32 v78, v110, v182
    v_mul_f32 v79, v111, v183
    v_fma_f32 v64, -v112, v152, v64
    v_fma_f32 v65, -v113, v153, v65
    v_cvt_pk_bf16_f32 v136, v64, v65
    v_fma_f32 v66, -v114, v154, v66
    v_fma_f32 v67, -v115, v155, v67
    v_cvt_pk_bf16_f32 v137, v66, v67
    v_fma_f32 v68, -v116, v156, v68
    v_fma_f32 v69, -v117, v157, v69
    v_cvt_pk_bf16_f32 v138, v68, v69
    v_fma_f32 v70, -v118, v158, v70
    v_fma_f32 v71, -v119, v159, v71
    v_cvt_pk_bf16_f32 v139, v70, v71
    v_fma_f32 v72, -v120, v160, v72
    v_fma_f32 v73, -v121, v161, v73
    v_cvt_pk_bf16_f32 v140, v72, v73
    v_fma_f32 v74, -v122, v162, v74
    v_fma_f32 v75, -v123, v163, v75
    v_cvt_pk_bf16_f32 v141, v74, v75
    v_fma_f32 v76, -v124, v164, v76
    v_fma_f32 v77, -v125, v165, v77
    v_cvt_pk_bf16_f32 v142, v76, v77
    v_fma_f32 v78, -v126, v166, v78
    v_fma_f32 v79, -v127, v167, v79
    v_cvt_pk_bf16_f32 v143, v78, v79
    v_mfma_f32_32x32x16_bf16 v[64:79], v[136:139], v[40:43], 0
    v_mul_f32 v112, v112, v168
    v_fma_f32 v112, -v96, v152, -v112
    v_mul_f32 v113, v113, v169
    v_fma_f32 v113, -v97, v153, -v113
    v_cvt_pk_bf16_f32 v144, v112, v113
    v_mul_f32 v114, v114, v170
    v_mfma_f32_32x32x16_bf16 v[64:79], v[140:143], v[44:47], v[64:79]
    v_fma_f32 v114, -v98, v154, -v114
    v_mul_f32 v115, v115, v171
    v_fma_f32 v115, -v99, v155, -v115
    v_cvt_pk_bf16_f32 v145, v114, v115
    v_mul_f32 v116, v116, v172
    v_fma_f32 v116, -v100, v156, -v116
    v_mfma_f32_32x32x16_bf16 v[80:95], v[136:139], v[56:59], 0
    v_mul_f32 v117, v117, v173
    v_fma_f32 v117, -v101, v157, -v117
    v_cvt_pk_bf16_f32 v146, v116, v117
    v_mul_f32 v118, v118, v174
    v_fma_f32 v118, -v102, v158, -v118
    v_mul_f32 v119, v119, v175
    v_mfma_f32_32x32x16_bf16 v[80:95], v[140:143], v[60:63], v[80:95]
    v_fma_f32 v119, -v103, v159, -v119
    v_cvt_pk_bf16_f32 v147, v118, v119
    v_mul_f32 v120, v120, v176
    v_fma_f32 v120, -v104, v160, -v120
    v_mul_f32 v121, v121, v177
    v_fma_f32 v121, -v105, v161, -v121
    v_cvt_pk_bf16_f32 v148, v120, v121
    v_mul_f32 v122, v122, v178
    v_fma_f32 v122, -v106, v162, -v122
    v_mul_f32 v123, v123, v179
    v_fma_f32 v123, -v107, v163, -v123
    v_cvt_pk_bf16_f32 v149, v122, v123
    v_mul_f32 v124, v124, v180
    v_fma_f32 v124, -v108, v164, -v124
    v_mul_f32 v125, v125, v181
    v_fma_f32 v125, -v109, v165, -v125
    v_cvt_pk_bf16_f32 v150, v124, v125
    v_mul_f32 v126, v126, v182
    v_fma_f32 v126, -v110, v166, -v126
    v_mul_f32 v127, v127, v183
    v_fma_f32 v127, -v111, v167, -v127
    v_cvt_pk_bf16_f32 v151, v126, v127
    v_mfma_f32_32x32x16_bf16 v[64:79], v[144:147], v[48:51], v[64:79]
    s_nop 0
    v_mfma_f32_32x32x16_bf16 v[64:79], v[148:151], v[52:55], v[64:79]
    v_mfma_f32_32x32x16_bf16 v[80:95], v[144:147], v[40:43], v[80:95]
    v_mfma_f32_32x32x16_bf16 v[80:95], v[148:151], v[44:47], v[80:95]
    s_nop 9
    v_cvt_pk_bf16_f32 v136, v64, v65
    v_cvt_pk_bf16_f32 v137, v66, v67
    v_cvt_pk_bf16_f32 v138, v68, v69
    v_cvt_pk_bf16_f32 v139, v70, v71
    v_cvt_pk_bf16_f32 v140, v72, v73
    v_cvt_pk_bf16_f32 v141, v74, v75
    v_cvt_pk_bf16_f32 v142, v76, v77
    v_cvt_pk_bf16_f32 v143, v78, v79
    v_mfma_f32_32x32x16_bf16 v[96:111], v[136:139], v[16:19], 0
    v_cvt_pk_bf16_f32 v144, v80, v81
    v_cvt_pk_bf16_f32 v145, v82, v83
    v_cvt_pk_bf16_f32 v146, v84, v85
    v_cvt_pk_bf16_f32 v147, v86, v87
    v_cvt_pk_bf16_f32 v148, v88, v89
    v_cvt_pk_bf16_f32 v149, v90, v91
    v_mfma_f32_32x32x16_bf16 v[96:111], v[140:143], v[20:23], v[96:111]
    v_cvt_pk_bf16_f32 v150, v92, v93
    v_cvt_pk_bf16_f32 v151, v94, v95
    v_mfma_f32_32x32x16_bf16 v[112:127], v[136:139], v[32:35], 0
    v_mfma_f32_32x32x16_bf16 v[112:127], v[140:143], v[36:39], v[112:127]
    v_mfma_f32_32x32x16_bf16 v[96:111], v[144:147], v[24:27], v[96:111]
    v_mfma_f32_32x32x16_bf16 v[96:111], v[148:151], v[28:31], v[96:111]
    v_mfma_f32_32x32x16_bf16 v[112:127], v[144:147], v[16:19], v[112:127]
    v_mfma_f32_32x32x16_bf16 v[112:127], v[148:151], v[20:23], v[112:127]
    s_nop 9
    ds_write_b128 v130, v[96:99] offset:0
    ds_write_b128 v131, v[100:103] offset:2048
    ds_write_b128 v128, v[104:107] offset:4096
    ds_write_b128 v129, v[108:111] offset:6144
    ds_write_b128 v130, v[112:115] offset:1024
    ds_write_b128 v131, v[116:119] offset:3072
    ds_write_b128 v128, v[120:123] offset:5120
    ds_write_b128 v129, v[124:127] offset:7168
    s_waitcnt lgkmcnt(0)
    v_mov_b32 v1, s64
    v_mov_b32 v2, 1
    s_mov_b64 exec, 1
    ds_add_u32 v1, v2
SWB_F:
    ds_read_b32 v2, v1
    s_waitcnt lgkmcnt(0)
    v_readfirstlane_b32 s48, v2
    s_nop 0
    s_cmp_lt_u32 s48, 4
    s_cbranch_scc1 SWB_F
    s_mov_b64 exec, -1
    ds_read_b128 v[64:67], v133 offset:0
    ds_read_b128 v[80:83], v133 offset:1024
    ds_read_b128 v[72:75], v133 offset:16384
    ds_read_b128 v[88:91], v133 offset:17408
    ds_read_b128 v[68:71], v133 offset:8192
    ds_read_b128 v[84:87], v133 offset:9216
    ds_read_b128 v[76:79], v133 offset:24576
    ds_read_b128 v[92:95], v133 offset:25600
    s_waitcnt lgkmcnt(5)
    v_add_f32 v96, v64, v72
    v_sub_f32 v100, v64, v72
    s_waitcnt lgkmcnt(4)
    v_add_f32 v112, v80, v88
    v_sub_f32 v116, v80, v88
    v_add_f32 v97, v65, v73
    v_sub_f32 v101, v65, v73
    v_add_f32 v113, v81, v89
    v_sub_f32 v117, v81, v89
    v_add_f32 v98, v66, v74
    v_sub_f32 v102, v66, v74
    v_add_f32 v114, v82, v90
    v_sub_f32 v118, v82, v90
    v_add_f32 v99, v67, v75
    v_sub_f32 v103, v67, v75
    v_add_f32 v115, v83, v91
    v_sub_f32 v119, v83, v91
    s_waitcnt lgkmcnt(1)
    v_add_f32 v104, v68, v76
    v_sub_f32 v108, v68, v76
    s_waitcnt lgkmcnt(0)
    v_add_f32 v120, v84, v92
    v_sub_f32 v124, v84, v92
    v_add_f32 v105, v69, v77
    v_sub_f32 v109, v69, v77
    v_add_f32 v121, v85, v93
    v_sub_f32 v125, v85, v93
    v_add_f32 v106, v70, v78
    v_sub_f32 v110, v70, v78
    v_add_f32 v122, v86, v94
    v_sub_f32 v126, v86, v94
    v_add_f32 v107, v71, v79
    v_sub_f32 v111, v71, v79
    v_add_f32 v123, v87, v95
    v_sub_f32 v127, v87, v95
    v_add_f32 v64, v96, v104
    v_add_f32 v80, v112, v120
    v_add_f32 v65, v97, v105
    v_add_f32 v81, v113, v121
    v_add_f32 v66, v98, v106
    v_add_f32 v82, v114, v122
    v_add_f32 v67, v99, v107
    v_add_f32 v83, v115, v123
    v_mul_f32 v152, v64, v184
    v_mul_f32 v153, v80, v184
    v_fmac_f32 v152, v80, v185
    v_fma_f32 v153, -v64, v185, v153
    v_cvt_pk_bf16_f32 v136, v152, v153
    v_mul_f32 v154, v65, v184
    v_mul_f32 v155, v81, v184
    v_fmac_f32 v154, v81, v185
    v_fma_f32 v155, -v65, v185, v155
    v_cvt_pk_bf16_f32 v137, v154, v155
    v_mul_f32 v156, v66, v184
    v_mul_f32 v157, v82, v184
    v_fmac_f32 v156, v82, v185
    v_fma_f32 v157, -v66, v185, v157
    v_cvt_pk_bf16_f32 v138, v156, v157
    v_mul_f32 v158, v67, v184
    v_mul_f32 v159, v83, v184
    v_fmac_f32 v158, v83, v185
    v_fma_f32 v159, -v67, v185, v159
    v_cvt_pk_bf16_f32 v139, v158, v159
    buffer_store_dwordx4 v[136:139], v132, s[44:47], s52 offen sc1
    s_add_u32 s52, s52, 16896
    v_add_f32 v68, v100, v124
    v_sub_f32 v84, v116, v108
    v_add_f32 v69, v101, v125
    v_sub_f32 v85, v117, v109
    v_add_f32 v70, v102, v126
    v_sub_f32 v86, v118, v110
    v_add_f32 v71, v103, v127
    v_sub_f32 v87, v119, v111
    v_mul_f32 v152, v68, v186
    v_mul_f32 v153, v84, v186
    v_fmac_f32 v152, v84, v187
    v_fma_f32 v153, -v68, v187, v153
    v_cvt_pk_bf16_f32 v140, v152, v153
    v_mul_f32 v154, v69, v186
    v_mul_f32 v155, v85, v186
    v_fmac_f32 v154, v85, v187
    v_fma_f32 v155, -v69, v187, v155
    v_cvt_pk_bf16_f32 v141, v154, v155
    v_mul_f32 v156, v70, v186
    v_mul_f32 v157, v86, v186
    v_fmac_f32 v156, v86, v187
    v_fma_f32 v157, -v70, v187, v157
    v_cvt_pk_bf16_f32 v142, v156, v157
    v_mul_f32 v158, v71, v186
    v_mul_f32 v159, v87, v186
    v_fmac_f32 v158, v87, v187
    v_fma_f32 v159, -v71, v187, v159
    v_cvt_pk_bf16_f32 v143, v158, v159
    buffer_store_dwordx4 v[140:143], v132, s[44:47], s52 offen sc1
    s_add_u32 s52, s52, 16896
    v_sub_f32 v72, v96, v104
    v_sub_f32 v88, v112, v120
    v_sub_f32 v73, v97, v105
    v_sub_f32 v89, v113, v121
    v_sub_f32 v74, v98, v106
    v_sub_f32 v90, v114, v122
    v_sub_f32 v75, v99, v107
    v_sub_f32 v91, v115, v123
    v_mul_f32 v152, v72, v188
    v_mul_f32 v153, v88, v188
    v_fmac_f32 v152, v88, v189
    v_fma_f32 v153, -v72, v189, v153
    v_cvt_pk_bf16_f32 v144, v152, v153
    v_mul_f32 v154, v73, v188
    v_mul_f32 v155, v89, v188
    v_fmac_f32 v154, v89, v189
    v_fma_f32 v155, -v73, v189, v155
    v_cvt_pk_bf16_f32 v145, v154, v155
    v_mul_f32 v156, v74, v188
    v_mul_f32 v157, v90, v188
    v_fmac_f32 v156, v90, v189
    v_fma_f32 v157, -v74, v189, v157
    v_cvt_pk_bf16_f32 v146, v156, v157
    v_mul_f32 v158, v75, v188
    v_mul_f32 v159, v91, v188
    v_fmac_f32 v158, v91, v189
    v_fma_f32 v159, -v75, v189, v159
    v_cvt_pk_bf16_f32 v147, v158, v159
    buffer_store_dwordx4 v[144:147], v132, s[44:47], s52 offen sc1
    s_add_u32 s52, s52, 16896
    v_sub_f32 v76, v100, v124
    v_add_f32 v92, v116, v108
    v_sub_f32 v77, v101, v125
    v_add_f32 v93, v117, v109
    v_sub_f32 v78, v102, v126
    v_add_f32 v94, v118, v110
    v_sub_f32 v79, v103, v127
    v_add_f32 v95, v119, v111
    v_mul_f32 v152, v76, v190
    v_mul_f32 v153, v92, v190
    v_fmac_f32 v152, v92, v191
    v_fma_f32 v153, -v76, v191, v153
    v_cvt_pk_bf16_f32 v148, v152, v153
    v_mul_f32 v154, v77, v190
    v_mul_f32 v155, v93, v190
    v_fmac_f32 v154, v93, v191
    v_fma_f32 v155, -v77, v191, v155
    v_cvt_pk_bf16_f32 v149, v154, v155
    v_mul_f32 v156, v78, v190
    v_mul_f32 v157, v94, v190
    v_fmac_f32 v156, v94, v191
    v_fma_f32 v157, -v78, v191, v157
    v_cvt_pk_bf16_f32 v150, v156, v157
    v_mul_f32 v158, v79, v190
    v_mul_f32 v159, v95, v190
    v_fmac_f32 v158, v95, v191
    v_fma_f32 v159, -v79, v191, v159
    v_cvt_pk_bf16_f32 v151, v158, v159
    buffer_store_dwordx4 v[148:151], v132, s[44:47], s52 offen sc1
    s_endpgm
K2_UP:
    s_and_b32 s50, s2, 0xe7
    s_cmp_eq_u32 s50, 64
    s_cbranch_scc1 K2_FFT
    s_cmp_ge_u32 s2, 64
    s_cbranch_scc1 K2_END
    s_cmp_lt_u32 s2, 32
    s_cbranch_scc1 K2_END
K2_KV:
    s_sub_u32 s49, s2, 32
    s_and_b32 s48, s49, 7
    s_lshr_b32 s52, s49, 4
    s_lshl_b32 s52, s52, 3
    s_add_u32 s48, s48, s52
    s_lshl_b32 s48, s48, 1
    s_bfe_u32 s52, s49, 0x10003
    s_add_u32 s16, s48, s52
    v_lshlrev_b32 v3, 4, v0
    s_lshl_b32 s48, s16, 15
    s_lshl_b32 s49, s20, 13
    s_add_u32 s48, s48, s49
    s_add_u32 s48, s48, 8388608
    s_add_u32 s49, s48, 4096
    buffer_load_dwordx4 v[8:11], v3, s[44:47], s48 offen offset:0
    buffer_load_dwordx4 v[12:15], v3, s[44:47], s48 offen offset:1024
    buffer_load_dwordx4 v[16:19], v3, s[44:47], s48 offen offset:2048
    buffer_load_dwordx4 v[20:23], v3, s[44:47], s48 offen offset:3072
    buffer_load_dwordx4 v[24:27], v3, s[44:47], s49 offen offset:0
    buffer_load_dwordx4 v[28:31], v3, s[44:47], s49 offen offset:1024
    buffer_load_dwordx4 v[32:35], v3, s[44:47], s49 offen offset:2048
    buffer_load_dwordx4 v[36:39], v3, s[44:47], s49 offen offset:3072
    v_lshrrev_b32 v1, 4, v0
    v_and_b32 v2, 15, v0
    v_lshlrev_b32 v4, 12, v1
    v_lshl_add_u32 v4, v2, 3, v4
    s_lshl_b32 s54, s16, 14
    s_lshl_b32 s55, s20, 8
    s_add_u32 s54, s54, s55
    buffer_load_dwordx2 v[40:41], v4, s[32:35], s54 offen offset:0
    buffer_load_dwordx2 v[42:43], v4, s[32:35], s54 offen offset:1024
    buffer_load_dwordx2 v[44:45], v4, s[32:35], s54 offen offset:2048
    buffer_load_dwordx2 v[46:47], v4, s[32:35], s54 offen offset:3072
    buffer_load_dwordx2 v[48:49], v4, s[32:35], s54 offen offset:128
    buffer_load_dwordx2 v[50:51], v4, s[32:35], s54 offen offset:1152
    buffer_load_dwordx2 v[52:53], v4, s[32:35], s54 offen offset:2176
    buffer_load_dwordx2 v[54:55], v4, s[32:35], s54 offen offset:3200
    s_lshl_b32 s48, s20, 10
    v_add_u32 v3, 69632, v3
    v_add_u32 v5, s48, v3
    v_lshrrev_b32 v56, 2, v2
    v_lshlrev_b32 v56, 14, v56
    v_and_b32 v6, 3, v2
    v_lshl_add_u32 v56, v6, 6, v56
    v_lshl_add_u32 v56, v1, 4, v56
    s_lshl_b32 s56, s20, 17
    s_lshr_b32 s49, s16, 1
    s_lshl_b32 s49, s49, 10
    s_add_u32 s56, s56, s49
    s_and_b32 s49, s16, 1
    s_lshl_b32 s49, s49, 8
    s_add_u32 s56, s56, s49
    s_add_u32 s56, s56, 12582912
    s_add_u32 s57, s56, 65536
    s_mov_b32 s52, 0x05040100
    s_mov_b32 s53, 0x07060302
    s_waitcnt vmcnt(14)
    v_add_f32 v8, v8, v12
    v_add_f32 v9, v9, v13
    v_add_f32 v10, v10, v14
    v_add_f32 v11, v11, v15
    s_waitcnt vmcnt(13)
    v_add_f32 v8, v8, v16
    v_add_f32 v9, v9, v17
    v_add_f32 v10, v10, v18
    v_add_f32 v11, v11, v19
    s_waitcnt vmcnt(12)
    v_add_f32 v8, v8, v20
    v_add_f32 v9, v9, v21
    v_add_f32 v10, v10, v22
    v_add_f32 v11, v11, v23
    s_waitcnt vmcnt(11)
    v_add_f32 v8, v8, v24
    v_add_f32 v9, v9, v25
    v_add_f32 v10, v10, v26
    v_add_f32 v11, v11, v27
    s_waitcnt vmcnt(10)
    v_add_f32 v8, v8, v28
    v_add_f32 v9, v9, v29
    v_add_f32 v10, v10, v30
    v_add_f32 v11, v11, v31
    s_waitcnt vmcnt(9)
    v_add_f32 v8, v8, v32
    v_add_f32 v9, v9, v33
    v_add_f32 v10, v10, v34
    v_add_f32 v11, v11, v35
    s_waitcnt vmcnt(8)
    v_add_f32 v8, v8, v36
    v_add_f32 v9, v9, v37
    v_add_f32 v10, v10, v38
    v_add_f32 v11, v11, v39
    ds_write_b128 v5, v[8:11]
    s_waitcnt vmcnt(6)
    v_perm_b32 v58, v42, v40, s52
    s_waitcnt vmcnt(4)
    v_perm_b32 v59, v46, v44, s52
    v_perm_b32 v60, v42, v40, s53
    v_perm_b32 v61, v46, v44, s53
    v_perm_b32 v62, v43, v41, s52
    v_perm_b32 v63, v47, v45, s52
    v_perm_b32 v64, v43, v41, s53
    v_perm_b32 v65, v47, v45, s53
    s_waitcnt vmcnt(2)
    v_perm_b32 v66, v50, v48, s52
    s_waitcnt vmcnt(0)
    v_perm_b32 v67, v54, v52, s52
    v_perm_b32 v68, v50, v48, s53
    v_perm_b32 v69, v54, v52, s53
    v_perm_b32 v70, v51, v49, s52
    v_perm_b32 v71, v55, v53, s52
    v_perm_b32 v72, v51, v49, s53
    v_perm_b32 v73, v55, v53, s53
    s_waitcnt lgkmcnt(0)
    v_mov_b32 v5, 16
    v_mov_b32 v6, 1
    s_mov_b64 exec, 1
    ds_add_u32 v5, v6
SWB_KV:
    ds_read_b32 v6, v5
    s_waitcnt lgkmcnt(0)
    v_readfirstlane_b32 s48, v6
    s_nop 0
    s_cmp_lt_u32 s48, 4
    s_cbranch_scc1 SWB_KV
    s_mov_b64 exec, -1
    ds_read_b128 v[12:15], v3 offset:0
    ds_read_b128 v[16:19], v3 offset:1024
    ds_read_b128 v[20:23], v3 offset:2048
    ds_read_b128 v[24:27], v3 offset:3072
    s_waitcnt lgkmcnt(2)
    v_add_f32 v12, v12, v16
    s_waitcnt lgkmcnt(0)
    v_add_f32 v20, v20, v24
    v_add_f32 v12, v12, v20
    v_add_f32 v13, v13, v17
    v_add_f32 v21, v21, v25
    v_add_f32 v13, v13, v21
    v_add_f32 v14, v14, v18
    v_add_f32 v22, v22, v26
    v_add_f32 v14, v14, v22
    v_add_f32 v15, v15, v19
    v_add_f32 v23, v23, v27
    v_add_f32 v15, v15, v23
    v_cvt_pk_bf16_f32 v124, v12, v13
    v_cvt_pk_bf16_f32 v125, v14, v15
    s_nop 1
    v_mfma_f32_16x16x16_bf16 v[76:79], v[124:125], v[58:59], 0
    v_mfma_f32_16x16x16_bf16 v[80:83], v[124:125], v[60:61], 0
    v_mfma_f32_16x16x16_bf16 v[84:87], v[124:125], v[62:63], 0
    v_mfma_f32_16x16x16_bf16 v[88:91], v[124:125], v[64:65], 0
    v_mfma_f32_16x16x16_bf16 v[92:95], v[124:125], v[66:67], 0
    v_mfma_f32_16x16x16_bf16 v[96:99], v[124:125], v[68:69], 0
    v_mfma_f32_16x16x16_bf16 v[100:103], v[124:125], v[70:71], 0
    v_mfma_f32_16x16x16_bf16 v[104:107], v[124:125], v[72:73], 0
    s_nop 0
    v_cvt_pk_bf16_f32 v108, v76, v77
    v_cvt_pk_bf16_f32 v109, v78, v79
    v_cvt_pk_bf16_f32 v110, v80, v81
    v_cvt_pk_bf16_f32 v111, v82, v83
    v_cvt_pk_bf16_f32 v112, v84, v85
    v_cvt_pk_bf16_f32 v113, v86, v87
    v_cvt_pk_bf16_f32 v114, v88, v89
    v_cvt_pk_bf16_f32 v115, v90, v91
    v_permlane16_swap_b32 v108, v110
    v_permlane16_swap_b32 v109, v111
    v_permlane16_swap_b32 v112, v114
    v_permlane16_swap_b32 v113, v115
    s_nop 0
    v_permlane32_swap_b32 v108, v112
    v_permlane32_swap_b32 v109, v113
    v_permlane32_swap_b32 v110, v114
    v_permlane32_swap_b32 v111, v115
    buffer_store_dwordx4 v[108:111], v56, s[44:47], s56 offen sc1
    buffer_store_dwordx4 v[112:115], v56, s[44:47], s56 offen offset:512 sc1
    v_cvt_pk_bf16_f32 v116, v92, v93
    v_cvt_pk_bf16_f32 v117, v94, v95
    v_cvt_pk_bf16_f32 v118, v96, v97
    v_cvt_pk_bf16_f32 v119, v98, v99
    v_cvt_pk_bf16_f32 v120, v100, v101
    v_cvt_pk_bf16_f32 v121, v102, v103
    v_cvt_pk_bf16_f32 v122, v104, v105
    v_cvt_pk_bf16_f32 v123, v106, v107
    v_permlane16_swap_b32 v116, v118
    v_permlane16_swap_b32 v117, v119
    v_permlane16_swap_b32 v120, v122
    v_permlane16_swap_b32 v121, v123
    s_nop 0
    v_permlane32_swap_b32 v116, v120
    v_permlane32_swap_b32 v117, v121
    v_permlane32_swap_b32 v118, v122
    v_permlane32_swap_b32 v119, v123
    buffer_store_dwordx4 v[116:119], v56, s[44:47], s57 offen sc1
    buffer_store_dwordx4 v[120:123], v56, s[44:47], s57 offen offset:512 sc1
    s_endpgm
K2_Q:
    s_lshr_b32 s23, s2, 3
    s_sub_u32 s23, s23, 16
    s_bfe_u32 s48, s2, 0x20001
    s_lshl_b32 s48, s48, 3
    s_lshr_b32 s18, s23, 1
    s_add_u32 s18, s18, s48
    s_and_b32 s48, s2, 1
    s_lshl_b32 s48, s48, 1
    s_and_b32 s16, s23, 1
    s_add_u32 s16, s16, s48
    v_lshrrev_b32 v1, 4, v0
    v_and_b32 v2, 15, v0
    s_and_b32 s48, s19, 1
    s_lshl_b32 s48, s48, 3
    v_xor_b32 v3, v1, v2
    v_xor_b32 v3, s48, v3
    v_lshlrev_b32 v3, 4, v3
    v_lshl_add_u32 v7, v1, 15, v3
    v_xor_b32 v8, 64, v7
    v_add_u32 v8, 130048, v8
    s_lshl_b32 s56, s18, 10
    s_lshl_b32 s57, s19, 18
    s_add_u32 s56, s56, s57
    s_lshl_b32 s57, s19, 11
    v_lshrrev_b32 v3, 3, v0
    v_bfe_u32 v4, v0, 4, 1
    v_bfe_u32 v5, v0, 1, 2
    v_xor_b32 v4, v4, v5
    v_lshlrev_b32 v4, 5, v4
    v_and_b32 v5, 1, v0
    v_lshl_add_u32 v4, v5, 4, v4
    v_mul_u32_u24 v3, 3072, v3
    v_add_u32 v9, v3, v4
    v_xor_b32 v10, 64, v9
    v_add_u32 v10, 23552, v10
    s_mul_i32 s58, s20, 49152
    s_lshl_b32 s59, s16, 8
    s_add_u32 s58, s58, s59
    s_lshr_b32 s59, s19, 2
    s_lshl_b32 s59, s59, 7
    s_add_u32 s58, s58, s59
    s_mov_b32 s24, s4
    s_mov_b32 s25, s5
    s_mov_b32 s26, 0x200000
    s_mov_b32 s27, 0x00020000
    s_mov_b32 s28, s6
    s_mov_b32 s29, s7
    s_mov_b32 s30, 0x180000
    s_mov_b32 s31, 0x00020000
    s_add_u32 m0, s57, 98304
    s_nop 0
    buffer_load_dwordx4 v7, s[24:27], s56 offen offset:0 lds
    buffer_load_dwordx4 v8, s[24:27], s56 offen offset:1024 lds
    s_add_u32 s56, s56, 256
    s_add_u32 m0, s57, 0
    s_nop 0
    buffer_load_dwordx4 v9, s[28:31], s58 offen offset:0 lds
    buffer_load_dwordx4 v10, s[28:31], s58 offen offset:1024 lds
    s_add_u32 s58, s58, 196608
    s_add_u32 m0, s57, 16384
    s_nop 0
    buffer_load_dwordx4 v9, s[28:31], s58 offen offset:0 lds
    buffer_load_dwordx4 v10, s[28:31], s58 offen offset:1024 lds
    s_add_u32 s58, s58, 196608
    s_add_u32 m0, s57, 114688
    s_nop 0
    buffer_load_dwordx4 v7, s[24:27], s56 offen offset:0 lds
    buffer_load_dwordx4 v8, s[24:27], s56 offen offset:1024 lds
    s_add_u32 s56, s56, 256
    s_lshl_b32 s17, s16, 3
    s_add_u32 s17, s17, s19
    v_lshlrev_b32 v21, 4, v0
    v_lshlrev_b32 v3, 8, v2
    v_add_u32 v3, 98304, v3
    v_xor_b32 v4, v1, v2
    v_lshl_add_u32 v22, v4, 4, v3
    v_xor_b32 v23, 64, v22
    v_xor_b32 v24, 128, v22
    v_xor_b32 v25, 192, v22
    v_bfe_u32 v3, v0, 2, 2
    v_bfe_u32 v4, v0, 3, 1
    v_and_b32 v5, 1, v1
    v_lshl_or_b32 v4, v5, 1, v4
    v_xor_b32 v4, s20, v4
    v_lshl_add_u32 v3, v1, 3, v3
    v_lshlrev_b32 v3, 7, v3
    v_lshl_add_u32 v3, v4, 5, v3
    v_and_b32 v4, 3, v0
    v_lshl_add_u32 v3, v4, 3, v3
    s_lshl_b32 s59, s59, 6
    v_add_u32 v26, s59, v3
    v_add_u32 v27, 49152, v26
    s_waitcnt vmcnt(4)
    s_barrier
    ds_read_b64_tr_b16 v[108:109], v26 offset:0
    ds_read_b64_tr_b16 v[110:111], v26 offset:512
    ds_read_b128 v[44:47], v22 offset:0
    ds_read_b128 v[48:51], v22 offset:4096
    ds_read_b128 v[52:55], v22 offset:8192
    ds_read_b128 v[56:59], v22 offset:12288
    ds_read_b64_tr_b16 v[112:113], v26 offset:4096
    ds_read_b64_tr_b16 v[114:115], v26 offset:4608
    ds_read_b128 v[60:63], v23 offset:0
    ds_read_b128 v[64:67], v23 offset:4096
    ds_read_b128 v[68:71], v23 offset:8192
    ds_read_b128 v[72:75], v23 offset:12288
    s_add_u32 m0, s57, 32768
    s_nop 0
    buffer_load_dwordx4 v9, s[28:31], s58 offen offset:0 lds
    buffer_load_dwordx4 v10, s[28:31], s58 offen offset:1024 lds
    s_add_u32 s58, s58, 196608
    s_add_u32 m0, s57, 49152
    s_nop 0
    buffer_load_dwordx4 v9, s[28:31], s58 offen offset:0 lds
    buffer_load_dwordx4 v10, s[28:31], s58 offen offset:1024 lds
    s_add_u32 s58, s58, 196608
    s_add_u32 m0, s57, 131072
    s_nop 0
    buffer_load_dwordx4 v7, s[24:27], s56 offen offset:0 lds
    buffer_load_dwordx4 v8, s[24:27], s56 offen offset:1024 lds
    s_add_u32 s56, s56, 256
    s_waitcnt vmcnt(8)
    s_waitcnt lgkmcnt(0)
    s_barrier
    v_mfma_f32_16x16x32_bf16 v[28:31], v[108:111], v[44:47], 0
    ds_read_b64_tr_b16 v[116:117], v26 offset:16384
    ds_read_b64_tr_b16 v[118:119], v26 offset:16896
    v_mfma_f32_16x16x32_bf16 v[32:35], v[108:111], v[48:51], 0
    ds_read_b128 v[76:79], v24 offset:0
    ds_read_b128 v[80:83], v24 offset:4096
    v_mfma_f32_16x16x32_bf16 v[36:39], v[108:111], v[52:55], 0
    ds_read_b128 v[84:87], v24 offset:8192
    ds_read_b128 v[88:91], v24 offset:12288
    v_mfma_f32_16x16x32_bf16 v[40:43], v[108:111], v[56:59], 0
    ds_read_b64_tr_b16 v[120:121], v26 offset:20480
    ds_read_b64_tr_b16 v[122:123], v26 offset:20992
    v_mfma_f32_16x16x32_bf16 v[28:31], v[112:115], v[60:63], v[28:31]
    ds_read_b128 v[92:95], v25 offset:0
    ds_read_b128 v[96:99], v25 offset:4096
    v_mfma_f32_16x16x32_bf16 v[32:35], v[112:115], v[64:67], v[32:35]
    ds_read_b128 v[100:103], v25 offset:8192
    ds_read_b128 v[104:107], v25 offset:12288
    v_mfma_f32_16x16x32_bf16 v[36:39], v[112:115], v[68:71], v[36:39]
    v_mfma_f32_16x16x32_bf16 v[40:43], v[112:115], v[72:75], v[40:43]
    s_add_u32 m0, s57, 65536
    s_nop 0
    buffer_load_dwordx4 v9, s[28:31], s58 offen offset:0 lds
    buffer_load_dwordx4 v10, s[28:31], s58 offen offset:1024 lds
    s_add_u32 s58, s58, 196608
    s_add_u32 m0, s57, 81920
    s_nop 0
    buffer_load_dwordx4 v9, s[28:31], s58 offen offset:0 lds
    buffer_load_dwordx4 v10, s[28:31], s58 offen offset:1024 lds
    s_add_u32 s58, s58, 196608
    s_waitcnt vmcnt(6)
    s_waitcnt lgkmcnt(0)
    s_barrier
    v_mfma_f32_16x16x32_bf16 v[28:31], v[116:119], v[76:79], v[28:31]
    ds_read_b64_tr_b16 v[108:109], v26 offset:32768
    ds_read_b64_tr_b16 v[110:111], v26 offset:33280
    v_mfma_f32_16x16x32_bf16 v[32:35], v[116:119], v[80:83], v[32:35]
    ds_read_b128 v[44:47], v22 offset:16384
    ds_read_b128 v[48:51], v22 offset:20480
    v_mfma_f32_16x16x32_bf16 v[36:39], v[116:119], v[84:87], v[36:39]
    ds_read_b128 v[52:55], v22 offset:24576
    ds_read_b128 v[56:59], v22 offset:28672
    v_mfma_f32_16x16x32_bf16 v[40:43], v[116:119], v[88:91], v[40:43]
    ds_read_b64_tr_b16 v[112:113], v26 offset:36864
    ds_read_b64_tr_b16 v[114:115], v26 offset:37376
    v_mfma_f32_16x16x32_bf16 v[28:31], v[120:123], v[92:95], v[28:31]
    ds_read_b128 v[60:63], v23 offset:16384
    ds_read_b128 v[64:67], v23 offset:20480
    v_mfma_f32_16x16x32_bf16 v[32:35], v[120:123], v[96:99], v[32:35]
    ds_read_b128 v[68:71], v23 offset:24576
    ds_read_b128 v[72:75], v23 offset:28672
    v_mfma_f32_16x16x32_bf16 v[36:39], v[120:123], v[100:103], v[36:39]
    v_mfma_f32_16x16x32_bf16 v[40:43], v[120:123], v[104:107], v[40:43]
    s_add_u32 m0, s57, 147456
    s_nop 0
    buffer_load_dwordx4 v7, s[24:27], s56 offen offset:0 lds
    buffer_load_dwordx4 v8, s[24:27], s56 offen offset:1024 lds
    s_add_u32 s56, s56, 256
    s_add_u32 m0, s57, 0
    s_nop 0
    buffer_load_dwordx4 v9, s[28:31], s58 offen offset:0 lds
    buffer_load_dwordx4 v10, s[28:31], s58 offen offset:1024 lds
    s_add_u32 s58, s58, 196608
    s_waitcnt lgkmcnt(9)
    v_mfma_f32_16x16x32_bf16 v[28:31], v[108:111], v[44:47], v[28:31]
    ds_read_b64_tr_b16 v[116:117], v27 offset:0
    ds_read_b64_tr_b16 v[118:119], v27 offset:512
    s_waitcnt lgkmcnt(10)
    v_mfma_f32_16x16x32_bf16 v[32:35], v[108:111], v[48:51], v[32:35]
    ds_read_b128 v[76:79], v24 offset:16384
    ds_read_b128 v[80:83], v24 offset:20480
    s_waitcnt lgkmcnt(11)
    v_mfma_f32_16x16x32_bf16 v[36:39], v[108:111], v[52:55], v[36:39]
    ds_read_b128 v[84:87], v24 offset:24576
    ds_read_b128 v[88:91], v24 offset:28672
    s_waitcnt lgkmcnt(12)
    v_mfma_f32_16x16x32_bf16 v[40:43], v[108:111], v[56:59], v[40:43]
    ds_read_b64_tr_b16 v[120:121], v27 offset:4096
    ds_read_b64_tr_b16 v[122:123], v27 offset:4608
    s_waitcnt lgkmcnt(11)
    v_mfma_f32_16x16x32_bf16 v[28:31], v[112:115], v[60:63], v[28:31]
    ds_read_b128 v[92:95], v25 offset:16384
    ds_read_b128 v[96:99], v25 offset:20480
    s_waitcnt lgkmcnt(12)
    v_mfma_f32_16x16x32_bf16 v[32:35], v[112:115], v[64:67], v[32:35]
    ds_read_b128 v[100:103], v25 offset:24576
    ds_read_b128 v[104:107], v25 offset:28672
    s_waitcnt lgkmcnt(13)
    v_mfma_f32_16x16x32_bf16 v[36:39], v[112:115], v[68:71], v[36:39]
    s_waitcnt lgkmcnt(12)
    v_mfma_f32_16x16x32_bf16 v[40:43], v[112:115], v[72:75], v[40:43]
    s_add_u32 m0, s57, 16384
    s_nop 0
    buffer_load_dwordx4 v9, s[28:31], s58 offen offset:0 lds
    buffer_load_dwordx4 v10, s[28:31], s58 offen offset:1024 lds
    s_add_u32 s58, s58, 196608
    s_lshl_b32 s50, s17, 11
    s_add_u32 s50, s50, 9437184
    buffer_load_dwordx4 v[12:15], v21, s[44:47], s50 offen
    buffer_load_dwordx4 v[16:19], v21, s[44:47], s50 offen offset:1024
    v_lshlrev_b32 v4, 2, v0
    s_lshl_b32 s50, s18, 8
    s_add_u32 s50, s50, 9568256
    buffer_load_dword v20, v4, s[44:47], s50 offen
    s_waitcnt vmcnt(9)
    s_waitcnt lgkmcnt(0)
    s_barrier
    v_mfma_f32_16x16x32_bf16 v[28:31], v[116:119], v[76:79], v[28:31]
    ds_read_b64_tr_b16 v[108:109], v27 offset:16384
    ds_read_b64_tr_b16 v[110:111], v27 offset:16896
    v_mfma_f32_16x16x32_bf16 v[32:35], v[116:119], v[80:83], v[32:35]
    ds_read_b128 v[44:47], v22 offset:32768
    ds_read_b128 v[48:51], v22 offset:36864
    v_mfma_f32_16x16x32_bf16 v[36:39], v[116:119], v[84:87], v[36:39]
    ds_read_b128 v[52:55], v22 offset:40960
    ds_read_b128 v[56:59], v22 offset:45056
    v_mfma_f32_16x16x32_bf16 v[40:43], v[116:119], v[88:91], v[40:43]
    ds_read_b64_tr_b16 v[112:113], v27 offset:20480
    ds_read_b64_tr_b16 v[114:115], v27 offset:20992
    v_mfma_f32_16x16x32_bf16 v[28:31], v[120:123], v[92:95], v[28:31]
    ds_read_b128 v[60:63], v23 offset:32768
    ds_read_b128 v[64:67], v23 offset:36864
    v_mfma_f32_16x16x32_bf16 v[32:35], v[120:123], v[96:99], v[32:35]
    ds_read_b128 v[68:71], v23 offset:40960
    ds_read_b128 v[72:75], v23 offset:45056
    v_mfma_f32_16x16x32_bf16 v[36:39], v[120:123], v[100:103], v[36:39]
    v_mfma_f32_16x16x32_bf16 v[40:43], v[120:123], v[104:107], v[40:43]
    s_waitcnt lgkmcnt(9)
    v_mfma_f32_16x16x32_bf16 v[28:31], v[108:111], v[44:47], v[28:31]
    ds_read_b64_tr_b16 v[116:117], v27 offset:32768
    ds_read_b64_tr_b16 v[118:119], v27 offset:33280
    s_waitcnt lgkmcnt(10)
    v_mfma_f32_16x16x32_bf16 v[32:35], v[108:111], v[48:51], v[32:35]
    ds_read_b128 v[76:79], v24 offset:32768
    ds_read_b128 v[80:83], v24 offset:36864
    s_waitcnt lgkmcnt(11)
    v_mfma_f32_16x16x32_bf16 v[36:39], v[108:111], v[52:55], v[36:39]
    ds_read_b128 v[84:87], v24 offset:40960
    ds_read_b128 v[88:91], v24 offset:45056
    s_waitcnt lgkmcnt(12)
    v_mfma_f32_16x16x32_bf16 v[40:43], v[108:111], v[56:59], v[40:43]
    ds_read_b64_tr_b16 v[120:121], v27 offset:36864
    ds_read_b64_tr_b16 v[122:123], v27 offset:37376
    s_waitcnt lgkmcnt(11)
    v_mfma_f32_16x16x32_bf16 v[28:31], v[112:115], v[60:63], v[28:31]
    ds_read_b128 v[92:95], v25 offset:32768
    ds_read_b128 v[96:99], v25 offset:36864
    s_waitcnt lgkmcnt(12)
    v_mfma_f32_16x16x32_bf16 v[32:35], v[112:115], v[64:67], v[32:35]
    ds_read_b128 v[100:103], v25 offset:40960
    ds_read_b128 v[104:107], v25 offset:45056
    s_waitcnt lgkmcnt(13)
    v_mfma_f32_16x16x32_bf16 v[36:39], v[112:115], v[68:71], v[36:39]
    s_waitcnt lgkmcnt(12)
    v_mfma_f32_16x16x32_bf16 v[40:43], v[112:115], v[72:75], v[40:43]
    s_waitcnt vmcnt(3)
    s_waitcnt lgkmcnt(0)
    s_barrier
    v_mfma_f32_16x16x32_bf16 v[28:31], v[116:119], v[76:79], v[28:31]
    ds_read_b64_tr_b16 v[108:109], v26 offset:0
    ds_read_b64_tr_b16 v[110:111], v26 offset:512
    v_mfma_f32_16x16x32_bf16 v[32:35], v[116:119], v[80:83], v[32:35]
    ds_read_b128 v[44:47], v22 offset:49152
    ds_read_b128 v[48:51], v22 offset:53248
    v_mfma_f32_16x16x32_bf16 v[36:39], v[116:119], v[84:87], v[36:39]
    ds_read_b128 v[52:55], v22 offset:57344
    ds_read_b128 v[56:59], v22 offset:61440
    v_mfma_f32_16x16x32_bf16 v[40:43], v[116:119], v[88:91], v[40:43]
    ds_read_b64_tr_b16 v[112:113], v26 offset:4096
    ds_read_b64_tr_b16 v[114:115], v26 offset:4608
    v_mfma_f32_16x16x32_bf16 v[28:31], v[120:123], v[92:95], v[28:31]
    ds_read_b128 v[60:63], v23 offset:49152
    ds_read_b128 v[64:67], v23 offset:53248
    v_mfma_f32_16x16x32_bf16 v[32:35], v[120:123], v[96:99], v[32:35]
    ds_read_b128 v[68:71], v23 offset:57344
    ds_read_b128 v[72:75], v23 offset:61440
    v_mfma_f32_16x16x32_bf16 v[36:39], v[120:123], v[100:103], v[36:39]
    v_mfma_f32_16x16x32_bf16 v[40:43], v[120:123], v[104:107], v[40:43]
    s_waitcnt lgkmcnt(9)
    v_mfma_f32_16x16x32_bf16 v[28:31], v[108:111], v[44:47], v[28:31]
    ds_read_b64_tr_b16 v[116:117], v26 offset:16384
    ds_read_b64_tr_b16 v[118:119], v26 offset:16896
    s_waitcnt lgkmcnt(10)
    v_mfma_f32_16x16x32_bf16 v[32:35], v[108:111], v[48:51], v[32:35]
    ds_read_b128 v[76:79], v24 offset:49152
    ds_read_b128 v[80:83], v24 offset:53248
    s_waitcnt lgkmcnt(11)
    v_mfma_f32_16x16x32_bf16 v[36:39], v[108:111], v[52:55], v[36:39]
    ds_read_b128 v[84:87], v24 offset:57344
    ds_read_b128 v[88:91], v24 offset:61440
    s_waitcnt lgkmcnt(12)
    v_mfma_f32_16x16x32_bf16 v[40:43], v[108:111], v[56:59], v[40:43]
    ds_read_b64_tr_b16 v[120:121], v26 offset:20480
    ds_read_b64_tr_b16 v[122:123], v26 offset:20992
    s_waitcnt lgkmcnt(11)
    v_mfma_f32_16x16x32_bf16 v[28:31], v[112:115], v[60:63], v[28:31]
    ds_read_b128 v[92:95], v25 offset:49152
    ds_read_b128 v[96:99], v25 offset:53248
    s_waitcnt lgkmcnt(12)
    v_mfma_f32_16x16x32_bf16 v[32:35], v[112:115], v[64:67], v[32:35]
    ds_read_b128 v[100:103], v25 offset:57344
    ds_read_b128 v[104:107], v25 offset:61440
    s_waitcnt lgkmcnt(13)
    v_mfma_f32_16x16x32_bf16 v[36:39], v[112:115], v[68:71], v[36:39]
    s_waitcnt lgkmcnt(12)
    v_mfma_f32_16x16x32_bf16 v[40:43], v[112:115], v[72:75], v[40:43]
    s_waitcnt vmcnt(1)
    v_add_f32 v12, v12, v16
    v_add_f32 v13, v13, v17
    v_add_f32 v14, v14, v18
    v_add_f32 v15, v15, v19
    v_add_f32_dpp v12, v12, v12 row_ror:8 row_mask:0xf bank_mask:0xf
    v_add_f32_dpp v13, v13, v13 row_ror:8 row_mask:0xf bank_mask:0xf
    v_add_f32_dpp v14, v14, v14 row_ror:8 row_mask:0xf bank_mask:0xf
    v_add_f32_dpp v15, v15, v15 row_ror:8 row_mask:0xf bank_mask:0xf
    v_add_f32_dpp v12, v12, v12 row_ror:4 row_mask:0xf bank_mask:0xf
    v_add_f32_dpp v13, v13, v13 row_ror:4 row_mask:0xf bank_mask:0xf
    v_add_f32_dpp v14, v14, v14 row_ror:4 row_mask:0xf bank_mask:0xf
    v_add_f32_dpp v15, v15, v15 row_ror:4 row_mask:0xf bank_mask:0xf
    v_mov_b32 v16, v12
    v_mov_b32 v17, v13
    v_mov_b32 v18, v14
    v_mov_b32 v19, v15
    v_permlane32_swap_b32 v12, v16
    v_permlane32_swap_b32 v13, v17
    v_permlane32_swap_b32 v14, v18
    v_permlane32_swap_b32 v15, v19
    v_add_f32 v12, v12, v16
    v_add_f32 v13, v13, v17
    v_add_f32 v14, v14, v18
    v_add_f32 v15, v15, v19
    v_mov_b32 v16, v12
    v_mov_b32 v17, v13
    v_mov_b32 v18, v14
    v_mov_b32 v19, v15
    v_permlane16_swap_b32 v12, v16
    v_permlane16_swap_b32 v13, v17
    v_permlane16_swap_b32 v14, v18
    v_permlane16_swap_b32 v15, v19
    v_add_f32 v12, v12, v16
    v_add_f32 v13, v13, v17
    v_add_f32 v14, v14, v18
    v_add_f32 v15, v15, v19
    v_cvt_pk_bf16_f32 v16, v12, v13
    v_cvt_pk_bf16_f32 v17, v14, v15
    v_lshlrev_b32 v3, 2, v1
    ds_bpermute_b32 v18, v3, v16
    ds_bpermute_b32 v19, v3, v17
    s_waitcnt lgkmcnt(1)
    v_lshlrev_b32 v12, 16, v18
    v_and_b32 v13, 0xffff0000, v18
    s_waitcnt lgkmcnt(0)
    v_lshlrev_b32 v14, 16, v19
    v_and_b32 v15, 0xffff0000, v19
    v_and_b32 v3, 1, v1
    v_lshlrev_b32 v21, 14, v3
    v_lshrrev_b32 v3, 1, v1
    v_lshl_add_u32 v21, v3, 9, v21
    v_lshl_add_u32 v21, v2, 4, v21
    s_lshl_b32 s50, s18, 16
    s_lshr_b32 s49, s17, 1
    s_lshl_b32 s49, s49, 10
    s_add_u32 s50, s50, s49
    s_and_b32 s49, s17, 1
    s_lshl_b32 s49, s49, 8
    s_add_u32 s50, s50, s49
    s_add_u32 s50, s50, 10485760
    s_add_u32 s51, s50, 32768
    v_mfma_f32_16x16x32_bf16 v[28:31], v[116:119], v[76:79], v[28:31]
    v_mfma_f32_16x16x32_bf16 v[32:35], v[116:119], v[80:83], v[32:35]
    v_mfma_f32_16x16x32_bf16 v[36:39], v[116:119], v[84:87], v[36:39]
    v_mfma_f32_16x16x32_bf16 v[40:43], v[116:119], v[88:91], v[40:43]
    v_mfma_f32_16x16x32_bf16 v[28:31], v[120:123], v[92:95], v[28:31]
    v_mfma_f32_16x16x32_bf16 v[32:35], v[120:123], v[96:99], v[32:35]
    v_mfma_f32_16x16x32_bf16 v[36:39], v[120:123], v[100:103], v[36:39]
    v_mfma_f32_16x16x32_bf16 v[40:43], v[120:123], v[104:107], v[40:43]
    v_mov_b32 v6, 0x3fb8aa3b
    s_nop 3
    v_cvt_pk_bf16_f32 v48, v28, v29
    v_cvt_pk_bf16_f32 v49, v30, v31
    v_lshlrev_b32 v28, 16, v48
    v_and_b32 v29, 0xffff0000, v48
    v_lshlrev_b32 v30, 16, v49
    v_and_b32 v31, 0xffff0000, v49
    v_mul_f32 v48, v6, v28
    v_mul_f32 v49, v6, v29
    v_mul_f32 v50, v6, v30
    v_mul_f32 v51, v6, v31
    v_exp_f32 v48, v48 clamp
    v_exp_f32 v49, v49 clamp
    v_exp_f32 v50, v50 clamp
    v_exp_f32 v51, v51 clamp
    v_max_f32 v28, 0x358637bd, v28
    v_max_f32 v29, 0x358637bd, v29
    v_max_f32 v30, 0x358637bd, v30
    v_max_f32 v31, 0x358637bd, v31
    v_add_f32 v28, v28, v48
    v_add_f32 v29, v29, v49
    v_add_f32 v30, v30, v50
    v_add_f32 v31, v31, v51
    v_cvt_pk_bf16_f32 v48, v28, v29
    v_cvt_pk_bf16_f32 v49, v30, v31
    v_lshlrev_b32 v28, 16, v48
    v_and_b32 v29, 0xffff0000, v48
    v_lshlrev_b32 v30, 16, v49
    v_and_b32 v31, 0xffff0000, v49
    v_mul_f32 v44, v28, v12
    v_fmac_f32 v44, v29, v13
    v_fmac_f32 v44, v30, v14
    v_fmac_f32 v44, v31, v15
    v_cvt_pk_bf16_f32 v48, v32, v33
    v_cvt_pk_bf16_f32 v49, v34, v35
    v_lshlrev_b32 v32, 16, v48
    v_and_b32 v33, 0xffff0000, v48
    v_lshlrev_b32 v34, 16, v49
    v_and_b32 v35, 0xffff0000, v49
    v_mul_f32 v48, v6, v32
    v_mul_f32 v49, v6, v33
    v_mul_f32 v50, v6, v34
    v_mul_f32 v51, v6, v35
    v_exp_f32 v48, v48 clamp
    v_exp_f32 v49, v49 clamp
    v_exp_f32 v50, v50 clamp
    v_exp_f32 v51, v51 clamp
    v_max_f32 v32, 0x358637bd, v32
    v_max_f32 v33, 0x358637bd, v33
    v_max_f32 v34, 0x358637bd, v34
    v_max_f32 v35, 0x358637bd, v35
    v_add_f32 v32, v32, v48
    v_add_f32 v33, v33, v49
    v_add_f32 v34, v34, v50
    v_add_f32 v35, v35, v51
    v_cvt_pk_bf16_f32 v48, v32, v33
    v_cvt_pk_bf16_f32 v49, v34, v35
    v_lshlrev_b32 v32, 16, v48
    v_and_b32 v33, 0xffff0000, v48
    v_lshlrev_b32 v34, 16, v49
    v_and_b32 v35, 0xffff0000, v49
    v_mul_f32 v45, v32, v12
    v_fmac_f32 v45, v33, v13
    v_fmac_f32 v45, v34, v14
    v_fmac_f32 v45, v35, v15
    v_cvt_pk_bf16_f32 v48, v36, v37
    v_cvt_pk_bf16_f32 v49, v38, v39
    v_lshlrev_b32 v36, 16, v48
    v_and_b32 v37, 0xffff0000, v48
    v_lshlrev_b32 v38, 16, v49
    v_and_b32 v39, 0xffff0000, v49
    v_mul_f32 v48, v6, v36
    v_mul_f32 v49, v6, v37
    v_mul_f32 v50, v6, v38
    v_mul_f32 v51, v6, v39
    v_exp_f32 v48, v48 clamp
    v_exp_f32 v49, v49 clamp
    v_exp_f32 v50, v50 clamp
    v_exp_f32 v51, v51 clamp
    v_max_f32 v36, 0x358637bd, v36
    v_max_f32 v37, 0x358637bd, v37
    v_max_f32 v38, 0x358637bd, v38
    v_max_f32 v39, 0x358637bd, v39
    v_add_f32 v36, v36, v48
    v_add_f32 v37, v37, v49
    v_add_f32 v38, v38, v50
    v_add_f32 v39, v39, v51
    v_cvt_pk_bf16_f32 v48, v36, v37
    v_cvt_pk_bf16_f32 v49, v38, v39
    v_lshlrev_b32 v36, 16, v48
    v_and_b32 v37, 0xffff0000, v48
    v_lshlrev_b32 v38, 16, v49
    v_and_b32 v39, 0xffff0000, v49
    v_mul_f32 v46, v36, v12
    v_fmac_f32 v46, v37, v13
    v_fmac_f32 v46, v38, v14
    v_fmac_f32 v46, v39, v15
    v_cvt_pk_bf16_f32 v48, v40, v41
    v_cvt_pk_bf16_f32 v49, v42, v43
    v_lshlrev_b32 v40, 16, v48
    v_and_b32 v41, 0xffff0000, v48
    v_lshlrev_b32 v42, 16, v49
    v_and_b32 v43, 0xffff0000, v49
    v_mul_f32 v48, v6, v40
    v_mul_f32 v49, v6, v41
    v_mul_f32 v50, v6, v42
    v_mul_f32 v51, v6, v43
    v_exp_f32 v48, v48 clamp
    v_exp_f32 v49, v49 clamp
    v_exp_f32 v50, v50 clamp
    v_exp_f32 v51, v51 clamp
    v_max_f32 v40, 0x358637bd, v40
    v_max_f32 v41, 0x358637bd, v41
    v_max_f32 v42, 0x358637bd, v42
    v_max_f32 v43, 0x358637bd, v43
    v_add_f32 v40, v40, v48
    v_add_f32 v41, v41, v49
    v_add_f32 v42, v42, v50
    v_add_f32 v43, v43, v51
    v_cvt_pk_bf16_f32 v48, v40, v41
    v_cvt_pk_bf16_f32 v49, v42, v43
    v_lshlrev_b32 v40, 16, v48
    v_and_b32 v41, 0xffff0000, v48
    v_lshlrev_b32 v42, 16, v49
    v_and_b32 v43, 0xffff0000, v49
    v_mul_f32 v47, v40, v12
    v_fmac_f32 v47, v41, v13
    v_fmac_f32 v47, v42, v14
    v_fmac_f32 v47, v43, v15
    v_permlane32_swap_b32 v44, v46
    s_nop 0
    v_permlane32_swap_b32 v45, v47
    v_add_f32 v44, v44, v46
    v_add_f32 v45, v45, v47
    s_nop 1
    v_permlane16_swap_b32 v44, v45
    v_add_f32 v44, v44, v45
    v_add_f32 v44, 0x358637bd, v44
    v_rcp_f32 v44, v44
    s_waitcnt vmcnt(0)
    v_mul_f32 v44, v44, v20
    v_mov_b32 v45, v44
    s_nop 1
    v_permlane16_swap_b32 v44, v45
    v_mov_b32 v46, v44
    v_mov_b32 v47, v45
    s_nop 0
    v_permlane32_swap_b32 v44, v46
    v_permlane32_swap_b32 v45, v47
    v_mul_f32 v28, v28, v44
    v_mul_f32 v29, v29, v44
    v_mul_f32 v30, v30, v44
    v_mul_f32 v31, v31, v44
    v_cvt_pk_bf16_f32 v52, v28, v29
    v_cvt_pk_bf16_f32 v53, v30, v31
    v_mul_f32 v32, v32, v45
    v_mul_f32 v33, v33, v45
    v_mul_f32 v34, v34, v45
    v_mul_f32 v35, v35, v45
    v_cvt_pk_bf16_f32 v54, v32, v33
    v_cvt_pk_bf16_f32 v55, v34, v35
    s_nop 0
    v_permlane16_swap_b32 v52, v54
    v_permlane16_swap_b32 v53, v55
    buffer_store_dwordx4 v[52:55], v21, s[44:47], s50 offen sc1
    v_mul_f32 v36, v36, v46
    v_mul_f32 v37, v37, v46
    v_mul_f32 v38, v38, v46
    v_mul_f32 v39, v39, v46
    v_cvt_pk_bf16_f32 v56, v36, v37
    v_cvt_pk_bf16_f32 v57, v38, v39
    v_mul_f32 v40, v40, v47
    v_mul_f32 v41, v41, v47
    v_mul_f32 v42, v42, v47
    v_mul_f32 v43, v43, v47
    v_cvt_pk_bf16_f32 v58, v40, v41
    v_cvt_pk_bf16_f32 v59, v42, v43
    s_nop 0
    v_permlane16_swap_b32 v56, v58
    v_permlane16_swap_b32 v57, v59
    buffer_store_dwordx4 v[56:59], v21, s[44:47], s51 offen sc1
K2_END:
    s_endpgm
.globl gm_k3_kernel
.p2align 8
.type gm_k3_kernel,@function
gm_k3_kernel:
    s_cmp_ge_u32 s2, 256
    s_cbranch_scc1 K3_END
    s_load_dwordx2 s[12:13], s[0:1], 56
    s_load_dwordx2 s[14:15], s[0:1], 72
    v_lshrrev_b32 v1, 6, v0
    v_and_b32 v0, 63, v0
    v_readfirstlane_b32 s20, v1
    s_bfe_u32 s16, s2, 0x20003
    s_and_b32 s21, s2, 1
    s_lshl_b32 s21, s21, 2
    s_add_u32 s16, s16, s21
    s_lshr_b32 s18, s2, 5
    s_bfe_u32 s21, s2, 0x20001
    s_lshl_b32 s21, s21, 3
    s_add_u32 s18, s18, s21
    v_lshlrev_b32 v3, 4, v0
    v_lshrrev_b32 v1, 4, v0
    v_and_b32 v2, 15, v0
    s_lshl_b32 s48, s18, 2
    s_lshr_b32 s49, s16, 1
    s_add_u32 s48, s48, s49
    s_mul_i32 s48, s48, 16896
    s_and_b32 s49, s16, 1
    s_lshl_b32 s49, s49, 6
    s_add_u32 s48, s48, s49
    s_add_u32 s51, s48, 13646336
    s_lshl_b32 s49, s20, 11
    s_add_u32 s53, s49, 49152
    s_mov_b32 m0, s53
    s_lshl_b32 s49, s20, 12
    s_add_u32 s48, s48, s49
    s_add_u32 s48, s48, 13631488
    s_add_u32 s50, s48, 1024
    v_lshrrev_b32 v4, 2, v0
    v_and_b32 v6, 3, v0
    v_lshlrev_b32 v6, 4, v6
    v_lshl_add_u32 v6, v4, 7, v6
    s_waitcnt lgkmcnt(0)
    s_mov_b32 s44, s14
    s_mov_b32 s45, s15
    s_mov_b32 s46, 0x1400000
    s_mov_b32 s47, 0x00020000
    buffer_load_dwordx4 v6, s[44:47], s48 offen lds
    buffer_load_dwordx4 v6, s[44:47], s50 offen offset:1024 lds
    s_mov_b32 m0, 57344
    s_cmp_lg_u32 s20, 0
    s_cbranch_scc1 K3_NOSPL
    buffer_load_dwordx4 v6, s[44:47], s51 offen lds
K3_NOSPL:
    s_add_u32 s66, s20, 0
    s_and_b32 s66, s66, 3
    s_add_u32 s67, s20, 1
    s_and_b32 s67, s67, 3
    s_add_u32 s68, s20, 2
    s_and_b32 s68, s68, 3
    s_add_u32 s69, s20, 3
    s_and_b32 s69, s69, 3
    v_lshlrev_b32 v5, 2, v2
    s_lshl_b32 s48, s18, 8
    s_add_u32 s48, s48, 9568256
    s_lshl_b32 s50, s66, 6
    s_add_u32 s50, s50, s48
    buffer_load_dword v10, v5, s[44:47], s50 offen
    s_lshl_b32 s50, s67, 6
    s_add_u32 s50, s50, s48
    buffer_load_dword v11, v5, s[44:47], s50 offen
    s_lshl_b32 s50, s68, 6
    s_add_u32 s50, s50, s48
    buffer_load_dword v12, v5, s[44:47], s50 offen
    s_lshl_b32 s50, s69, 6
    s_add_u32 s50, s50, s48
    buffer_load_dword v13, v5, s[44:47], s50 offen
    s_lshl_b32 s48, s18, 16
    s_add_u32 s48, s48, s49
    s_add_u32 s48, s48, 10485760
    s_lshl_b32 s70, s66, 14
    s_add_u32 s70, s70, s48
    s_lshl_b32 s71, s67, 14
    s_add_u32 s71, s71, s48
    s_lshl_b32 s72, s68, 14
    s_add_u32 s72, s72, s48
    s_lshl_b32 s73, s69, 14
    s_add_u32 s73, s73, s48
    s_lshl_b32 s54, s16, 14
    s_add_u32 s54, s54, s49
    s_add_u32 s54, s54, 12582912
    s_add_u32 s55, s54, 131072
    s_add_u32 s56, s54, 262144
    s_add_u32 s57, s54, 393216
    buffer_load_dwordx4 a[0:3], v3, s[44:47], s70 offen offset:0
    buffer_load_dwordx4 a[64:67], v3, s[44:47], s54 offen offset:0
    buffer_load_dwordx4 a[4:7], v3, s[44:47], s71 offen offset:0
    buffer_load_dwordx4 a[68:71], v3, s[44:47], s55 offen offset:0
    buffer_load_dwordx4 a[8:11], v3, s[44:47], s72 offen offset:0
    buffer_load_dwordx4 a[72:75], v3, s[44:47], s56 offen offset:0
    buffer_load_dwordx4 a[12:15], v3, s[44:47], s73 offen offset:0
    buffer_load_dwordx4 a[76:79], v3, s[44:47], s57 offen offset:0
    buffer_load_dwordx4 a[16:19], v3, s[44:47], s70 offen offset:1024
    buffer_load_dwordx4 a[80:83], v3, s[44:47], s54 offen offset:1024
    buffer_load_dwordx4 a[20:23], v3, s[44:47], s71 offen offset:1024
    v_mov_b32 v14, 0x0000bf80
    v_mov_b32 v15, 0xbf800000
    s_mov_b32 s40, s12
    s_mov_b32 s41, s13
    s_mov_b32 s42, 0x200000
    s_mov_b32 s43, 0x00020000
    s_cmp_eq_u32 s20, 0
    s_cselect_b64 s[64:65], 0xffff, 0
    s_lshl_b32 s52, s20, 3
    v_lshl_add_u32 v4, v1, 1, s52
    v_lshl_add_u32 v5, v2, 5, s18
    v_cvt_f32_u32 v5, v5
    v_mul_f32 v5, 0x3a000000, v5
    v_cvt_f32_u32 v48, v4
    v_add_f32 v49, 1.0, v48
    v_mul_f32 v50, v5, v48
    v_mul_f32 v48, 0x3e800000, v48
    buffer_load_dwordx4 a[84:87], v3, s[44:47], s55 offen offset:1024
    v_mul_f32 v51, v5, v49
    v_mul_f32 v49, 0x3e800000, v49
    v_lshlrev_b32 v52, 31, v2
    v_or_b32 v52, 0.5, v52
    v_cvt_f32_u32 v6, s66
    v_fma_f32 v4, v6, v48, v50
    v_cos_f32 v54, v4
    v_sin_f32 v55, v4
    v_fma_f32 v4, v6, v49, v51
    v_cos_f32 v56, v4
    v_sin_f32 v57, v4
    v_cvt_f32_u32 v6, s67
    v_fma_f32 v4, v6, v48, v50
    v_cos_f32 v58, v4
    v_sin_f32 v59, v4
    v_fma_f32 v4, v6, v49, v51
    buffer_load_dwordx4 a[24:27], v3, s[44:47], s72 offen offset:1024
    v_cos_f32 v60, v4
    v_sin_f32 v61, v4
    v_cvt_f32_u32 v6, s68
    v_fma_f32 v4, v6, v48, v50
    v_cos_f32 v62, v4
    v_sin_f32 v63, v4
    v_fma_f32 v4, v6, v49, v51
    v_cos_f32 v64, v4
    v_sin_f32 v65, v4
    v_cvt_f32_u32 v6, s69
    v_fma_f32 v4, v6, v48, v50
    v_cos_f32 v66, v4
    v_sin_f32 v67, v4
    v_fma_f32 v4, v6, v49, v51
    v_cos_f32 v68, v4
    v_sin_f32 v69, v4
    buffer_load_dwordx4 a[88:91], v3, s[44:47], s56 offen offset:1024
    s_mov_b64 exec, s[64:65]
    v_mov_b32 v54, 0.5
    v_mov_b32 v55, v52
    v_mov_b32 v58, 0.5
    v_mov_b32 v59, v52
    v_mov_b32 v62, 0.5
    v_mov_b32 v63, v52
    v_mov_b32 v66, 0.5
    v_mov_b32 v67, v52
    s_mov_b64 exec, -1
    s_waitcnt vmcnt(17)
    v_sub_f32 v4, 1.0, v10
    v_cvt_pk_bf16_f32 v4, v4, v4
    v_and_b32 v4, 0xffff0000, v4
    v_mul_f32 v4, 0x36000000, v4
    v_mul_f32 v54, v54, v4
    v_mul_f32 v55, v55, v4
    v_mul_f32 v56, v56, v4
    v_mul_f32 v57, v57, v4
    s_waitcnt vmcnt(16)
    v_sub_f32 v4, 1.0, v11
    v_cvt_pk_bf16_f32 v4, v4, v4
    v_and_b32 v4, 0xffff0000, v4
    v_mul_f32 v4, 0x36000000, v4
    v_mul_f32 v58, v58, v4
    v_mul_f32 v59, v59, v4
    v_mul_f32 v60, v60, v4
    buffer_load_dwordx4 a[28:31], v3, s[44:47], s73 offen offset:1024
    v_mul_f32 v61, v61, v4
    s_waitcnt vmcnt(16)
    v_sub_f32 v4, 1.0, v12
    v_cvt_pk_bf16_f32 v4, v4, v4
    v_and_b32 v4, 0xffff0000, v4
    v_mul_f32 v4, 0x36000000, v4
    v_mul_f32 v62, v62, v4
    v_mul_f32 v63, v63, v4
    v_mul_f32 v64, v64, v4
    v_mul_f32 v65, v65, v4
    s_waitcnt vmcnt(15)
    v_sub_f32 v4, 1.0, v13
    v_cvt_pk_bf16_f32 v4, v4, v4
    v_and_b32 v4, 0xffff0000, v4
    v_mul_f32 v4, 0x36000000, v4
    v_mul_f32 v66, v66, v4
    v_mul_f32 v67, v67, v4
    v_mul_f32 v68, v68, v4
    buffer_load_dwordx4 a[92:95], v3, s[44:47], s57 offen offset:1024
    v_mul_f32 v69, v69, v4
    v_cvt_pk_bf16_f32 v16, v54, v55
    v_mov_b32 v18, v16
    v_cvt_pk_bf16_f32 v17, v56, v57
    v_mov_b32 v19, v17
    v_cvt_pk_bf16_f32 v24, v58, v59
    v_mov_b32 v26, v24
    v_cvt_pk_bf16_f32 v25, v60, v61
    v_mov_b32 v27, v25
    v_cvt_pk_bf16_f32 v32, v62, v63
    v_mov_b32 v34, v32
    v_cvt_pk_bf16_f32 v33, v64, v65
    v_mov_b32 v35, v33
    v_cvt_pk_bf16_f32 v40, v66, v67
    v_mov_b32 v42, v40
    v_cvt_pk_bf16_f32 v41, v68, v69
    buffer_load_dwordx4 a[32:35], v3, s[44:47], s70 offen offset:2048
    v_mov_b32 v43, v41
    v_dot2c_f32_bf16 v54, v16, v14
    v_dot2c_f32_bf16 v55, v16, v15
    v_dot2c_f32_bf16 v56, v17, v14
    v_dot2c_f32_bf16 v57, v17, v15
    v_dot2c_f32_bf16 v58, v24, v14
    v_dot2c_f32_bf16 v59, v24, v15
    v_dot2c_f32_bf16 v60, v25, v14
    v_dot2c_f32_bf16 v61, v25, v15
    v_dot2c_f32_bf16 v62, v32, v14
    v_dot2c_f32_bf16 v63, v32, v15
    v_dot2c_f32_bf16 v64, v33, v14
    v_dot2c_f32_bf16 v65, v33, v15
    v_dot2c_f32_bf16 v66, v40, v14
    v_dot2c_f32_bf16 v67, v40, v15
    v_dot2c_f32_bf16 v68, v41, v14
    buffer_load_dwordx4 a[96:99], v3, s[44:47], s54 offen offset:2048
    v_dot2c_f32_bf16 v69, v41, v15
    v_cvt_pk_bf16_f32 v20, v54, v55
    v_mov_b32 v22, v20
    v_cvt_pk_bf16_f32 v21, v56, v57
    v_mov_b32 v23, v21
    v_cvt_pk_bf16_f32 v28, v58, v59
    v_mov_b32 v30, v28
    v_cvt_pk_bf16_f32 v29, v60, v61
    v_mov_b32 v31, v29
    v_cvt_pk_bf16_f32 v36, v62, v63
    v_mov_b32 v38, v36
    v_cvt_pk_bf16_f32 v37, v64, v65
    v_mov_b32 v39, v37
    v_cvt_pk_bf16_f32 v44, v66, v67
    v_mov_b32 v46, v44
    v_cvt_pk_bf16_f32 v45, v68, v69
    buffer_load_dwordx4 a[36:39], v3, s[44:47], s71 offen offset:2048
    v_mov_b32 v47, v45
    v_lshlrev_b32 v4, 2, v2
    v_add_u32 v71, 58112, v4
    v_lshl_add_u32 v4, v1, 9, v4
    v_add_u32 v70, s53, v4
    ds_read2_b32 v[96:97], v70 offset0:0 offset1:16
    ds_read2_b32 v[98:99], v70 offset0:32 offset1:48
    ds_read2_b32 v[100:101], v70 offset0:64 offset1:80
    ds_read2_b32 v[102:103], v70 offset0:96 offset1:112
    ds_read2_b32 v[104:105], v71 offset0:0 offset1:16
    ds_read2_b32 v[106:107], v71 offset0:32 offset1:48
    s_waitcnt lgkmcnt(5)
    v_lshlrev_b32 v72, 16, v96
    v_and_b32 v73, 0xffff0000, v96
    v_lshlrev_b32 v74, 16, v97
    v_and_b32 v75, 0xffff0000, v97
    s_waitcnt lgkmcnt(4)
    v_lshlrev_b32 v76, 16, v98
    buffer_load_dwordx4 a[100:103], v3, s[44:47], s55 offen offset:2048
    v_and_b32 v77, 0xffff0000, v98
    v_lshlrev_b32 v78, 16, v99
    v_and_b32 v79, 0xffff0000, v99
    s_waitcnt lgkmcnt(3)
    v_lshlrev_b32 v80, 16, v100
    v_and_b32 v81, 0xffff0000, v100
    v_lshlrev_b32 v82, 16, v101
    v_and_b32 v83, 0xffff0000, v101
    s_waitcnt lgkmcnt(2)
    v_lshlrev_b32 v84, 16, v102
    v_and_b32 v85, 0xffff0000, v102
    v_lshlrev_b32 v86, 16, v103
    v_and_b32 v87, 0xffff0000, v103
    s_waitcnt lgkmcnt(1)
    v_lshlrev_b32 v88, 16, v104
    v_and_b32 v89, 0xffff0000, v104
    v_lshlrev_b32 v90, 16, v105
    v_and_b32 v91, 0xffff0000, v105
    s_waitcnt lgkmcnt(0)
    v_lshlrev_b32 v92, 16, v106
    buffer_load_dwordx4 a[40:43], v3, s[44:47], s72 offen offset:2048
    v_and_b32 v93, 0xffff0000, v106
    v_lshlrev_b32 v94, 16, v107
    v_and_b32 v95, 0xffff0000, v107
    v_add_f32 v124, v72, v76
    v_sub_f32 v126, v72, v76
    v_add_f32 v128, v74, v78
    v_sub_f32 v130, v74, v78
    v_add_f32 v125, v73, v77
    v_sub_f32 v127, v73, v77
    v_add_f32 v129, v75, v79
    v_sub_f32 v131, v75, v79
    v_add_f32 v108, v124, v128
    v_sub_f32 v116, v124, v128
    v_add_f32 v109, v125, v129
    v_sub_f32 v117, v125, v129
    v_add_f32 v112, v126, v131
    buffer_load_dwordx4 a[104:107], v3, s[44:47], s56 offen offset:2048
    v_sub_f32 v113, v127, v130
    v_sub_f32 v120, v126, v131
    v_add_f32 v121, v127, v130
    v_add_f32 v124, v80, v84
    v_sub_f32 v126, v80, v84
    v_add_f32 v128, v82, v86
    v_sub_f32 v130, v82, v86
    v_add_f32 v125, v81, v85
    v_sub_f32 v127, v81, v85
    v_add_f32 v129, v83, v87
    v_sub_f32 v131, v83, v87
    v_add_f32 v110, v124, v128
    v_sub_f32 v118, v124, v128
    v_add_f32 v111, v125, v129
    v_sub_f32 v119, v125, v129
    v_add_f32 v114, v126, v131
    buffer_load_dwordx4 a[44:47], v3, s[44:47], s73 offen offset:2048
    v_sub_f32 v115, v127, v130
    v_sub_f32 v122, v126, v131
    v_add_f32 v123, v127, v130
    s_mov_b64 exec, s[64:65]
    v_add_f32 v124, v88, v92
    v_sub_f32 v126, v88, v92
    v_add_f32 v128, v90, v94
    v_sub_f32 v131, v91, v95
    v_add_f32 v109, v124, v128
    v_sub_f32 v117, v124, v128
    v_add_f32 v113, v126, v131
    v_sub_f32 v121, v126, v131
    s_mov_b64 exec, -1
    v_cvt_pk_bf16_f32 v132, v108, v109
    v_cvt_pk_bf16_f32 v133, v110, v111
    v_cvt_pk_bf16_f32 v136, v112, v113
    v_cvt_pk_bf16_f32 v137, v114, v115
    v_cvt_pk_bf16_f32 v140, v116, v117
    v_cvt_pk_bf16_f32 v141, v118, v119
    v_cvt_pk_bf16_f32 v144, v120, v121
    v_cvt_pk_bf16_f32 v145, v122, v123
    v_dot2c_f32_bf16 v108, v132, v14
    v_dot2c_f32_bf16 v109, v132, v15
    v_dot2c_f32_bf16 v110, v133, v14
    v_dot2c_f32_bf16 v111, v133, v15
    buffer_load_dwordx4 a[108:111], v3, s[44:47], s57 offen offset:2048
    v_dot2c_f32_bf16 v112, v136, v14
    v_dot2c_f32_bf16 v113, v136, v15
    v_dot2c_f32_bf16 v114, v137, v14
    v_dot2c_f32_bf16 v115, v137, v15
    v_dot2c_f32_bf16 v116, v140, v14
    v_dot2c_f32_bf16 v117, v140, v15
    v_dot2c_f32_bf16 v118, v141, v14
    v_dot2c_f32_bf16 v119, v141, v15
    v_dot2c_f32_bf16 v120, v144, v14
    v_dot2c_f32_bf16 v121, v144, v15
    v_dot2c_f32_bf16 v122, v145, v14
    v_dot2c_f32_bf16 v123, v145, v15
    v_cvt_pk_bf16_f32 v134, v108, v109
    v_cvt_pk_bf16_f32 v135, v110, v111
    v_cvt_pk_bf16_f32 v138, v112, v113
    v_cvt_pk_bf16_f32 v139, v114, v115
    buffer_load_dwordx4 a[48:51], v3, s[44:47], s70 offen offset:3072
    v_cvt_pk_bf16_f32 v142, v116, v117
    v_cvt_pk_bf16_f32 v143, v118, v119
    v_cvt_pk_bf16_f32 v146, v120, v121
    v_cvt_pk_bf16_f32 v147, v122, v123
    v_mfma_f32_16x16x32_bf16 a[128:131], v[132:135], v[16:19], 0
    v_mfma_f32_16x16x32_bf16 a[144:147], v[132:135], v[24:27], 0
    v_mfma_f32_16x16x32_bf16 a[160:163], v[132:135], v[32:35], 0
    v_mfma_f32_16x16x32_bf16 a[176:179], v[132:135], v[40:43], 0
    v_mfma_f32_16x16x32_bf16 a[132:135], v[136:139], v[16:19], 0
    v_mfma_f32_16x16x32_bf16 a[148:151], v[136:139], v[24:27], 0
    v_mfma_f32_16x16x32_bf16 a[164:167], v[136:139], v[32:35], 0
    v_mfma_f32_16x16x32_bf16 a[180:183], v[136:139], v[40:43], 0
    v_mfma_f32_16x16x32_bf16 a[136:139], v[140:143], v[16:19], 0
    v_mfma_f32_16x16x32_bf16 a[152:155], v[140:143], v[24:27], 0
    v_mfma_f32_16x16x32_bf16 a[168:171], v[140:143], v[32:35], 0
    v_mfma_f32_16x16x32_bf16 a[184:187], v[140:143], v[40:43], 0
    buffer_load_dwordx4 a[112:115], v3, s[44:47], s54 offen offset:3072
    v_mfma_f32_16x16x32_bf16 a[140:143], v[144:147], v[16:19], 0
    v_mfma_f32_16x16x32_bf16 a[156:159], v[144:147], v[24:27], 0
    v_mfma_f32_16x16x32_bf16 a[172:175], v[144:147], v[32:35], 0
    v_mfma_f32_16x16x32_bf16 a[188:191], v[144:147], v[40:43], 0
    v_mfma_f32_16x16x32_bf16 a[128:131], v[132:135], v[20:23], a[128:131]
    v_mfma_f32_16x16x32_bf16 a[144:147], v[132:135], v[28:31], a[144:147]
    v_mfma_f32_16x16x32_bf16 a[160:163], v[132:135], v[36:39], a[160:163]
    v_mfma_f32_16x16x32_bf16 a[176:179], v[132:135], v[44:47], a[176:179]
    v_mfma_f32_16x16x32_bf16 a[132:135], v[136:139], v[20:23], a[132:135]
    v_mfma_f32_16x16x32_bf16 a[148:151], v[136:139], v[28:31], a[148:151]
    v_mfma_f32_16x16x32_bf16 a[164:167], v[136:139], v[36:39], a[164:167]
    v_mfma_f32_16x16x32_bf16 a[180:183], v[136:139], v[44:47], a[180:183]
    v_mfma_f32_16x16x32_bf16 a[136:139], v[140:143], v[20:23], a[136:139]
    v_mfma_f32_16x16x32_bf16 a[152:155], v[140:143], v[28:31], a[152:155]
    v_mfma_f32_16x16x32_bf16 a[168:171], v[140:143], v[36:39], a[168:171]
    v_mfma_f32_16x16x32_bf16 a[184:187], v[140:143], v[44:47], a[184:187]
    buffer_load_dwordx4 a[52:55], v3, s[44:47], s71 offen offset:3072
    v_mfma_f32_16x16x32_bf16 a[140:143], v[144:147], v[20:23], a[140:143]
    v_mfma_f32_16x16x32_bf16 a[156:159], v[144:147], v[28:31], a[156:159]
    v_mfma_f32_16x16x32_bf16 a[172:175], v[144:147], v[36:39], a[172:175]
    v_mfma_f32_16x16x32_bf16 a[188:191], v[144:147], v[44:47], a[188:191]
    s_mul_i32 s48, s20, 12288
    v_add_u32 v4, s48, v3
    s_sub_u32 s48, s20, 1
    s_and_b32 s48, s48, 3
    s_mul_i32 s48, s48, 12288
    v_add_u32 v5, s48, v3
    s_sub_u32 s48, s20, 2
    s_and_b32 s48, s48, 3
    s_mul_i32 s48, s48, 12288
    v_add_u32 v6, s48, v3
    s_sub_u32 s48, s20, 3
    s_and_b32 s48, s48, 3
    buffer_load_dwordx4 a[116:119], v3, s[44:47], s55 offen offset:3072
    s_mul_i32 s48, s48, 12288
    v_add_u32 v7, s48, v3
    v_lshlrev_b32 v148, 15, v2
    v_lshl_add_u32 v148, v1, 3, v148
    s_lshl_b32 s48, s20, 9
    s_add_u32 s48, s48, s18
    s_lshl_b32 s48, s48, 10
    s_lshl_b32 s49, s16, 5
    s_add_u32 s48, s48, s49
    buffer_load_dwordx4 a[56:59], v3, s[44:47], s72 offen offset:3072
    s_waitcnt vmcnt(27)
    v_mfma_f32_16x16x32_bf16 a[128:131], a[64:67], a[0:3], a[128:131]
    s_waitcnt vmcnt(25)
    v_mfma_f32_16x16x32_bf16 a[132:135], a[68:71], a[0:3], a[132:135]
    s_waitcnt vmcnt(23)
    v_mfma_f32_16x16x32_bf16 a[136:139], a[72:75], a[0:3], a[136:139]
    s_waitcnt vmcnt(21)
    v_mfma_f32_16x16x32_bf16 a[140:143], a[76:79], a[0:3], a[140:143]
    buffer_load_dwordx4 a[120:123], v3, s[44:47], s56 offen offset:3072
    v_mfma_f32_16x16x32_bf16 a[144:147], a[64:67], a[4:7], a[144:147]
    v_mfma_f32_16x16x32_bf16 a[148:151], a[68:71], a[4:7], a[148:151]
    v_mfma_f32_16x16x32_bf16 a[152:155], a[72:75], a[4:7], a[152:155]
    v_mfma_f32_16x16x32_bf16 a[156:159], a[76:79], a[4:7], a[156:159]
    buffer_load_dwordx4 a[60:63], v3, s[44:47], s73 offen offset:3072
    v_mfma_f32_16x16x32_bf16 a[160:163], a[64:67], a[8:11], a[160:163]
    v_mfma_f32_16x16x32_bf16 a[164:167], a[68:71], a[8:11], a[164:167]
    v_mfma_f32_16x16x32_bf16 a[168:171], a[72:75], a[8:11], a[168:171]
    v_mfma_f32_16x16x32_bf16 a[172:175], a[76:79], a[8:11], a[172:175]
    buffer_load_dwordx4 a[124:127], v3, s[44:47], s57 offen offset:3072
    v_mfma_f32_16x16x32_bf16 a[176:179], a[64:67], a[12:15], a[176:179]
    v_mfma_f32_16x16x32_bf16 a[180:183], a[68:71], a[12:15], a[180:183]
    v_mfma_f32_16x16x32_bf16 a[184:187], a[72:75], a[12:15], a[184:187]
    v_mfma_f32_16x16x32_bf16 a[188:191], a[76:79], a[12:15], a[188:191]
    s_waitcnt vmcnt(22)
    v_mfma_f32_16x16x32_bf16 a[128:131], a[80:83], a[16:19], a[128:131]
    s_waitcnt vmcnt(20)
    v_mfma_f32_16x16x32_bf16 a[132:135], a[84:87], a[16:19], a[132:135]
    s_waitcnt vmcnt(18)
    v_mfma_f32_16x16x32_bf16 a[136:139], a[88:91], a[16:19], a[136:139]
    s_waitcnt vmcnt(16)
    v_mfma_f32_16x16x32_bf16 a[140:143], a[92:95], a[16:19], a[140:143]
    v_mfma_f32_16x16x32_bf16 a[144:147], a[80:83], a[20:23], a[144:147]
    v_mfma_f32_16x16x32_bf16 a[148:151], a[84:87], a[20:23], a[148:151]
    v_mfma_f32_16x16x32_bf16 a[152:155], a[88:91], a[20:23], a[152:155]
    v_mfma_f32_16x16x32_bf16 a[156:159], a[92:95], a[20:23], a[156:159]
    v_mfma_f32_16x16x32_bf16 a[160:163], a[80:83], a[24:27], a[160:163]
    v_mfma_f32_16x16x32_bf16 a[164:167], a[84:87], a[24:27], a[164:167]
    v_mfma_f32_16x16x32_bf16 a[168:171], a[88:91], a[24:27], a[168:171]
    v_mfma_f32_16x16x32_bf16 a[172:175], a[92:95], a[24:27], a[172:175]
    v_mfma_f32_16x16x32_bf16 a[176:179], a[80:83], a[28:31], a[176:179]
    v_mfma_f32_16x16x32_bf16 a[180:183], a[84:87], a[28:31], a[180:183]
    v_mfma_f32_16x16x32_bf16 a[184:187], a[88:91], a[28:31], a[184:187]
    v_mfma_f32_16x16x32_bf16 a[188:191], a[92:95], a[28:31], a[188:191]
    s_waitcnt vmcnt(14)
    v_mfma_f32_16x16x32_bf16 a[128:131], a[96:99], a[32:35], a[128:131]
    s_waitcnt vmcnt(12)
    v_mfma_f32_16x16x32_bf16 a[132:135], a[100:103], a[32:35], a[132:135]
    s_waitcnt vmcnt(10)
    v_mfma_f32_16x16x32_bf16 a[136:139], a[104:107], a[32:35], a[136:139]
    s_waitcnt vmcnt(8)
    v_mfma_f32_16x16x32_bf16 a[140:143], a[108:111], a[32:35], a[140:143]
    v_mfma_f32_16x16x32_bf16 a[144:147], a[96:99], a[36:39], a[144:147]
    v_mfma_f32_16x16x32_bf16 a[148:151], a[100:103], a[36:39], a[148:151]
    v_mfma_f32_16x16x32_bf16 a[152:155], a[104:107], a[36:39], a[152:155]
    v_mfma_f32_16x16x32_bf16 a[156:159], a[108:111], a[36:39], a[156:159]
    v_mfma_f32_16x16x32_bf16 a[160:163], a[96:99], a[40:43], a[160:163]
    v_mfma_f32_16x16x32_bf16 a[164:167], a[100:103], a[40:43], a[164:167]
    v_mfma_f32_16x16x32_bf16 a[168:171], a[104:107], a[40:43], a[168:171]
    v_mfma_f32_16x16x32_bf16 a[172:175], a[108:111], a[40:43], a[172:175]
    v_mfma_f32_16x16x32_bf16 a[176:179], a[96:99], a[44:47], a[176:179]
    v_mfma_f32_16x16x32_bf16 a[180:183], a[100:103], a[44:47], a[180:183]
    v_mfma_f32_16x16x32_bf16 a[184:187], a[104:107], a[44:47], a[184:187]
    v_mfma_f32_16x16x32_bf16 a[188:191], a[108:111], a[44:47], a[188:191]
    s_waitcnt vmcnt(5)
    v_mfma_f32_16x16x32_bf16 a[144:147], a[112:115], a[52:55], a[144:147]
    s_waitcnt vmcnt(4)
    v_mfma_f32_16x16x32_bf16 a[148:151], a[116:119], a[52:55], a[148:151]
    s_waitcnt vmcnt(2)
    v_mfma_f32_16x16x32_bf16 a[152:155], a[120:123], a[52:55], a[152:155]
    s_waitcnt vmcnt(0)
    v_mfma_f32_16x16x32_bf16 a[156:159], a[124:127], a[52:55], a[156:159]
    v_mfma_f32_16x16x32_bf16 a[160:163], a[112:115], a[56:59], a[160:163]
    v_mfma_f32_16x16x32_bf16 a[164:167], a[116:119], a[56:59], a[164:167]
    v_mfma_f32_16x16x32_bf16 a[168:171], a[120:123], a[56:59], a[168:171]
    v_mfma_f32_16x16x32_bf16 a[172:175], a[124:127], a[56:59], a[172:175]
    ds_write_b128 v4, a[144:147] offset:0
    ds_write_b128 v4, a[148:151] offset:1024
    ds_write_b128 v4, a[152:155] offset:2048
    s_nop 0
    ds_write_b128 v4, a[156:159] offset:3072
    v_mfma_f32_16x16x32_bf16 a[176:179], a[112:115], a[60:63], a[176:179]
    v_mfma_f32_16x16x32_bf16 a[180:183], a[116:119], a[60:63], a[180:183]
    v_mfma_f32_16x16x32_bf16 a[184:187], a[120:123], a[60:63], a[184:187]
    v_mfma_f32_16x16x32_bf16 a[188:191], a[124:127], a[60:63], a[188:191]
    ds_write_b128 v4, a[160:163] offset:4096
    ds_write_b128 v4, a[164:167] offset:5120
    ds_write_b128 v4, a[168:171] offset:6144
    ds_write_b128 v4, a[172:175] offset:7168
    v_mfma_f32_16x16x32_bf16 a[128:131], a[112:115], a[48:51], a[128:131]
    v_mfma_f32_16x16x32_bf16 a[132:135], a[116:119], a[48:51], a[132:135]
    v_mfma_f32_16x16x32_bf16 a[136:139], a[120:123], a[48:51], a[136:139]
    v_mfma_f32_16x16x32_bf16 a[140:143], a[124:127], a[48:51], a[140:143]
    ds_write_b128 v4, a[176:179] offset:8192
    ds_write_b128 v4, a[180:183] offset:9216
    ds_write_b128 v4, a[184:187] offset:10240
    ds_write_b128 v4, a[188:191] offset:11264
    s_nop 0
    v_accvgpr_read_b32 v152, a128
    v_accvgpr_read_b32 v153, a129
    v_accvgpr_read_b32 v154, a130
    v_accvgpr_read_b32 v155, a131
    v_accvgpr_read_b32 v156, a132
    v_accvgpr_read_b32 v157, a133
    v_accvgpr_read_b32 v158, a134
    v_accvgpr_read_b32 v159, a135
    v_accvgpr_read_b32 v160, a136
    v_accvgpr_read_b32 v161, a137
    v_accvgpr_read_b32 v162, a138
    v_accvgpr_read_b32 v163, a139
    v_accvgpr_read_b32 v164, a140
    v_accvgpr_read_b32 v165, a141
    v_accvgpr_read_b32 v166, a142
    v_accvgpr_read_b32 v167, a143
    s_waitcnt lgkmcnt(0)
    s_barrier
    ds_read_b128 v[168:171], v5 offset:0
    ds_read_b128 v[172:175], v6 offset:4096
    ds_read_b128 v[176:179], v7 offset:8192
    ds_read_b128 v[180:183], v5 offset:1024
    ds_read_b128 v[184:187], v6 offset:5120
    ds_read_b128 v[188:191], v7 offset:9216
    ds_read_b128 v[192:195], v5 offset:2048
    ds_read_b128 v[196:199], v6 offset:6144
    ds_read_b128 v[200:203], v7 offset:10240
    ds_read_b128 v[204:207], v5 offset:3072
    ds_read_b128 v[208:211], v6 offset:7168
    ds_read_b128 v[212:215], v7 offset:11264
    s_waitcnt lgkmcnt(11)
    v_add_f32 v152, v152, v168
    s_waitcnt lgkmcnt(9)
    v_add_f32 v172, v172, v176
    v_add_f32 v153, v153, v169
    v_add_f32 v173, v173, v177
    v_add_f32 v154, v154, v170
    v_add_f32 v174, v174, v178
    v_add_f32 v155, v155, v171
    v_add_f32 v175, v175, v179
    v_add_f32 v152, v152, v172
    v_add_f32 v153, v153, v173
    v_add_f32 v154, v154, v174
    v_add_f32 v155, v155, v175
    v_cvt_pk_bf16_f32 v168, v152, v153
    v_cvt_pk_bf16_f32 v169, v154, v155
    buffer_store_dwordx2 v[168:169], v148, s[40:43], s48 offen offset:0
    s_waitcnt lgkmcnt(8)
    v_add_f32 v156, v156, v180
    s_waitcnt lgkmcnt(6)
    v_add_f32 v184, v184, v188
    v_add_f32 v157, v157, v181
    v_add_f32 v185, v185, v189
    v_add_f32 v158, v158, v182
    v_add_f32 v186, v186, v190
    v_add_f32 v159, v159, v183
    v_add_f32 v187, v187, v191
    v_add_f32 v156, v156, v184
    v_add_f32 v157, v157, v185
    v_add_f32 v158, v158, v186
    v_add_f32 v159, v159, v187
    v_cvt_pk_bf16_f32 v180, v156, v157
    v_cvt_pk_bf16_f32 v181, v158, v159
    buffer_store_dwordx2 v[180:181], v148, s[40:43], s48 offen offset:256
    s_waitcnt lgkmcnt(5)
    v_add_f32 v160, v160, v192
    s_waitcnt lgkmcnt(3)
    v_add_f32 v196, v196, v200
    v_add_f32 v161, v161, v193
    v_add_f32 v197, v197, v201
    v_add_f32 v162, v162, v194
    v_add_f32 v198, v198, v202
    v_add_f32 v163, v163, v195
    v_add_f32 v199, v199, v203
    v_add_f32 v160, v160, v196
    v_add_f32 v161, v161, v197
    v_add_f32 v162, v162, v198
    v_add_f32 v163, v163, v199
    v_cvt_pk_bf16_f32 v192, v160, v161
    v_cvt_pk_bf16_f32 v193, v162, v163
    buffer_store_dwordx2 v[192:193], v148, s[40:43], s48 offen offset:512
    s_waitcnt lgkmcnt(2)
    v_add_f32 v164, v164, v204
    s_waitcnt lgkmcnt(0)
    v_add_f32 v208, v208, v212
    v_add_f32 v165, v165, v205
    v_add_f32 v209, v209, v213
    v_add_f32 v166, v166, v206
    v_add_f32 v210, v210, v214
    v_add_f32 v167, v167, v207
    v_add_f32 v211, v211, v215
    v_add_f32 v164, v164, v208
    v_add_f32 v165, v165, v209
    v_add_f32 v166, v166, v210
    v_add_f32 v167, v167, v211
    v_cvt_pk_bf16_f32 v204, v164, v165
    v_cvt_pk_bf16_f32 v205, v166, v167
    buffer_store_dwordx2 v[204:205], v148, s[40:43], s48 offen offset:768
K3_END:
    s_endpgm
GM_CODE_END:
.section .rodata,"a"
.p2align 6
.Lgm_kd:
.p2align 6
.amdhsa_kernel gm_k1_kernel
  .amdhsa_next_free_vgpr 168
  .amdhsa_next_free_sgpr 100
  .amdhsa_accum_offset 168
  .amdhsa_group_segment_fixed_size 0
  .amdhsa_kernarg_size 80
  .amdhsa_user_sgpr_count 2
  .amdhsa_user_sgpr_kernarg_segment_ptr 1
  .amdhsa_system_sgpr_workgroup_id_x 1
.end_amdhsa_kernel
.p2align 6
.amdhsa_kernel gm_k2_kernel
  .amdhsa_next_free_vgpr 192
  .amdhsa_next_free_sgpr 100
  .amdhsa_accum_offset 192
  .amdhsa_group_segment_fixed_size 0
  .amdhsa_kernarg_size 80
  .amdhsa_user_sgpr_count 2
  .amdhsa_user_sgpr_kernarg_segment_ptr 1
  .amdhsa_system_sgpr_workgroup_id_x 1
.end_amdhsa_kernel
.p2align 6
.amdhsa_kernel gm_k3_kernel
  .amdhsa_next_free_vgpr 408
  .amdhsa_next_free_sgpr 100
  .amdhsa_accum_offset 216
  .amdhsa_group_segment_fixed_size 0
  .amdhsa_kernarg_size 80
  .amdhsa_user_sgpr_count 2
  .amdhsa_user_sgpr_kernarg_segment_ptr 1
  .amdhsa_system_sgpr_workgroup_id_x 1
.end_amdhsa_kernel
```
